```python
import torch

def _softmax(x, axis=-1):
    return torch.softmax(x, dim=axis)
def _gelu(x):
    return torch.nn.functional.gelu(x, approximate="tanh")
def _silu(x):
    return torch.nn.functional.silu(x)
def _sigmoid(x):
    return torch.sigmoid(x)
def _layernorm(x, axis=-1, eps=1e-5):
    m = x.mean(dim=axis, keepdim=True)
    v = x.var(dim=axis, keepdim=True, unbiased=False)
    return (x - m) / torch.sqrt(v + eps)
def _scatter_add(tgt, idx, src, axis=0):
    return tgt.clone().index_add_(axis, idx, src)
def _segment_sum(src, seg, n):
    out = torch.zeros((n,) + src.shape[1:], dtype=src.dtype)
    return out.index_add_(0, seg, src)
def _pad(x, pw):
    flat = tuple(v for pair in reversed(pw) for v in pair)
    return torch.nn.functional.pad(x, flat)

kernel_name = 'sequential_preLN__linear_attn_block__dense_activation_gelu__prompt'

def setup_inputs():

    _w = (lambda a: (lambda t: t.to(torch.bfloat16) if t.is_floating_point() else t)(torch.as_tensor(a)))
    def _A_setup():
        B, S, D = 1, 2048, 640
        return {
            "x": _w((lambda *s: torch.randn(*s, dtype=torch.bfloat16) * 0.05)(B, S, D)),
            "wqkv": _w((lambda *s: torch.randn(*s, dtype=torch.bfloat16) * 0.05)(D, 3 * D)),
            "wo": _w((lambda *s: torch.randn(*s, dtype=torch.bfloat16) * 0.05)(D, D)),
        }
    _A_in = _A_setup()

    def _B_setup():
        B, S, D, F = 1, 2048, 640, 1536
        return {
            "x": _w((lambda *s: torch.randn(*s, dtype=torch.bfloat16) * 0.05)(B, S, D)),
            "w1": _w((lambda *s: torch.randn(*s, dtype=torch.bfloat16) * 0.8)(D, F) * (D ** -0.5)),
            "b1": _w((lambda *s: torch.randn(*s, dtype=torch.bfloat16) * 12.8)(F) * 0.01),
            "w2": _w((lambda *s: torch.randn(*s, dtype=torch.bfloat16) * 0.2)(F, D) * (F ** -0.5)),
            "b2": _w((lambda *s: torch.randn(*s, dtype=torch.bfloat16) * 3.2)(D) * 0.01),
        }
    _B_in = _B_setup()

    return {
        "A_x": _A_in["x"],
        "A_wqkv": _A_in["wqkv"],
        "A_wo": _A_in["wo"],
        "B_x": _B_in["x"],
        "B_w1": _B_in["w1"],
        "B_b1": _B_in["b1"],
        "B_w2": _B_in["w2"],
        "B_b2": _B_in["b2"],
    }

def reference(A_x, A_wqkv, A_wo, B_x, B_w1, B_b1, B_w2, B_b2):
    def _A_ref(x, wqkv, wo):
        B, S, D = x.shape
        H = 32; Dh = D // H
        qkv = (lambda x, *d: x.permute(*d))((x @ wqkv).reshape(B, S, 3, H, Dh), 2, 0, 3, 1, 4)
        q, k, v = qkv[0], qkv[1], qkv[2]
        phi = lambda t: torch.where(t > 0, t + 1, torch.exp(t)) + 1e-6
        pq, pk = phi(q), phi(k)
        kv = torch.einsum("bhsd,bhse->bhde", pk, v)
        z = torch.einsum("bhsd->bhd", pk)
        num = torch.einsum("bhqd,bhde->bhqe", pq, kv)
        den = torch.einsum("bhqd,bhd->bhq", pq, z)[..., None] + 1e-6
        o = num / den
        return (lambda x, *d: x.permute(*d))(o, 0, 2, 1, 3).reshape(B, S, D) @ wo

    def _B_ref(x, w1, b1, w2, b2):
        h = torch.einsum("bsd,df->bsf", x, w1) + b1
        h = _gelu(h)
        return torch.einsum("bsf,fd->bsd", h, w2) + b2

    x = A_x
    h = x + _A_ref(_layernorm(x, axis=-1), A_wqkv, A_wo)
    h2 = h + _B_ref(_layernorm(h, axis=-1), B_w1, B_b1, B_w2, B_b2)
    return h2
```

```asm
; @launch kernel=p1_kernel grid=(256,1,1) block=(512,1,1) lds=163840
; @launch kernel=k2_kernel grid=(256,1,1) block=(256,1,1) lds=163840
.amdgcn_target "amdgcn-amd-amdhsa--gfx950"
.text
.p2align 8
.globl p1_kernel
.type p1_kernel,@function
p1_kernel:
    s_cmp_ge_u32 s2, 256
    s_cbranch_scc1 P1_END
    s_load_dwordx4 s[4:7], s[0:1], 0
    s_load_dwordx4 s[8:11], s[0:1], 72
    s_load_dwordx2 s[20:21], s[0:1], 16
    s_load_dwordx2 s[22:23], s[0:1], 32
    s_load_dwordx2 s[24:25], s[0:1], 48
    s_and_b32 s32, s2, 7
    s_lshr_b32 s33, s2, 3
    v_lshrrev_b32 v2, 6, v0
    v_and_b32 v3, 63, v0
    v_readfirstlane_b32 s36, v2
    v_lshlrev_b32 v1, 4, v3
    v_and_b32 v4, 15, v3
    v_lshrrev_b32 v5, 4, v3
    v_bfe_u32 v6, v3, 2, 2
    v_and_b32 v7, 3, v3
    s_and_b32 s37, s36, 3
    s_lshr_b32 s38, s37, 1
    s_and_b32 s39, s37, 1
    v_mov_b32 v12, 0x3f803f80
    v_mov_b32 v13, 0x3f803f80
    v_mov_b32 v14, 0x3f803f80
    v_mov_b32 v15, 0x3f803f80
    s_cmp_ge_u32 s33, 22
    s_cbranch_scc1 P1_Q
    s_lshr_b32 s34, s32, 2
    s_mul_i32 s35, s34, 11
    s_lshr_b32 s44, s33, 1
    s_add_u32 s35, s35, s44
    s_and_b32 s34, s32, 3
    s_lshl_b32 s34, s34, 1
    s_and_b32 s44, s33, 1
    s_add_u32 s34, s34, s44
    s_cmp_lt_u32 s36, 4
    s_cbranch_scc1 P1_KVC
    v_lshrrev_b32 v26, 3, v3
    v_and_b32 v27, 7, v3
    v_xor_b32 v27, v27, v26
    v_and_b32 v27, 7, v27
    v_lshlrev_b32 v27, 4, v27
    v_mul_u32_u24 v16, 1280, v26
    v_add_u32 v16, v16, v27
    v_add_u32 v17, 9216, v16
    v_add_u32 v18, 18432, v16
    s_mul_i32 s60, s37, 3072
    v_add_u32 v32, s60, v1
    s_mul_i32 s61, s35, 95
    s_mul_i32 s62, s37, 24
    s_add_u32 s61, s61, s62
    s_mul_i32 s61, s61, 1280
    s_mul_i32 s63, s37, 5120
    s_add_u32 s63, s63, 12288
    s_mov_b32 s62, 0
    s_mul_i32 s38, s35, 0x199a
    s_lshr_b32 s38, s38, 16
    s_mul_i32 s38, s38, 10
    s_sub_u32 s38, s35, s38
    s_lshl_b32 s39, s38, 7
    s_add_u32 s61, s61, s39
    s_mul_i32 s39, s38, 245760
    s_add_u32 s62, s62, s39
    s_mov_b32 s56, 0
    s_mov_b32 s70, -1
    s_cmp_eq_u32 s37, 3
    s_cselect_b32 s71, 0x00ffffff, -1
    s_mul_i32 s44, s37, 320
    s_mul_i32 s45, s34, 160
    s_mov_b32 s46, 0xcccd
    v_add_u32 v26, s44, v3
    v_mul_lo_u32 v27, v26, s46
    v_lshrrev_b32 v27, 20, v27
    v_mul_u32_u24 v28, 20, v27
    v_sub_u32 v28, v26, v28
    v_bfe_u32 v29, v27, 3, 1
    v_lshlrev_b32 v29, 1, v29
    v_xor_b32 v28, v28, v29
    v_cmp_le_u32 vcc, 10, v28
    v_mov_b32 v29, 5376
    v_mov_b32 v30, 6496
    v_cndmask_b32 v29, v29, v30, vcc
    v_lshl_add_u32 v29, v28, 4, v29
    v_add_u32 v29, s45, v29
    v_mul_u32_u24 v20, 3840, v27
    v_add_u32 v20, v20, v29
    v_subrev_u32 v20, 4096, v20
    v_add_u32 v26, s44, v3
    v_add_u32 v26, 64, v26
    v_mul_lo_u32 v27, v26, s46
    v_lshrrev_b32 v27, 20, v27
    v_mul_u32_u24 v28, 20, v27
    v_sub_u32 v28, v26, v28
    v_bfe_u32 v29, v27, 3, 1
    v_lshlrev_b32 v29, 1, v29
    v_xor_b32 v28, v28, v29
    v_cmp_le_u32 vcc, 10, v28
    v_mov_b32 v29, 4352
    v_mov_b32 v30, 5472
    v_cndmask_b32 v29, v29, v30, vcc
    v_lshl_add_u32 v29, v28, 4, v29
    v_add_u32 v29, s45, v29
    v_mul_u32_u24 v21, 3840, v27
    v_add_u32 v21, v21, v29
    v_subrev_u32 v21, 4096, v21
    v_add_u32 v26, s44, v3
    v_add_u32 v26, 128, v26
    v_mul_lo_u32 v27, v26, s46
    v_lshrrev_b32 v27, 20, v27
    v_mul_u32_u24 v28, 20, v27
    v_sub_u32 v28, v26, v28
    v_bfe_u32 v29, v27, 3, 1
    v_lshlrev_b32 v29, 1, v29
    v_xor_b32 v28, v28, v29
    v_cmp_le_u32 vcc, 10, v28
    v_mov_b32 v29, 3328
    v_mov_b32 v30, 4448
    v_cndmask_b32 v29, v29, v30, vcc
    v_lshl_add_u32 v29, v28, 4, v29
    v_add_u32 v29, s45, v29
    v_mul_u32_u24 v22, 3840, v27
    v_add_u32 v22, v22, v29
    v_subrev_u32 v22, 4096, v22
    v_add_u32 v26, s44, v3
    v_add_u32 v26, 192, v26
    v_mul_lo_u32 v27, v26, s46
    v_lshrrev_b32 v27, 20, v27
    v_mul_u32_u24 v28, 20, v27
    v_sub_u32 v28, v26, v28
    v_bfe_u32 v29, v27, 3, 1
    v_lshlrev_b32 v29, 1, v29
    v_xor_b32 v28, v28, v29
    v_cmp_le_u32 vcc, 10, v28
    v_mov_b32 v29, 2304
    v_mov_b32 v30, 3424
    v_cndmask_b32 v29, v29, v30, vcc
    v_lshl_add_u32 v29, v28, 4, v29
    v_add_u32 v29, s45, v29
    v_mul_u32_u24 v23, 3840, v27
    v_add_u32 v23, v23, v29
    v_subrev_u32 v23, 4096, v23
    v_add_u32 v26, s44, v3
    v_add_u32 v26, 256, v26
    v_mul_lo_u32 v27, v26, s46
    v_lshrrev_b32 v27, 20, v27
    v_mul_u32_u24 v28, 20, v27
    v_sub_u32 v28, v26, v28
    v_bfe_u32 v29, v27, 3, 1
    v_lshlrev_b32 v29, 1, v29
    v_xor_b32 v28, v28, v29
    v_cmp_le_u32 vcc, 10, v28
    v_mov_b32 v29, 5376
    v_mov_b32 v30, 6496
    v_cndmask_b32 v29, v29, v30, vcc
    v_lshl_add_u32 v29, v28, 4, v29
    v_add_u32 v29, s45, v29
    v_mul_u32_u24 v24, 3840, v27
    v_add_u32 v24, v24, v29
    v_subrev_u32 v24, 4096, v24
    s_waitcnt lgkmcnt(0)
    s_mov_b32 s12, s4
    s_mov_b32 s13, s5
    s_mov_b32 s14, 0x280000
    s_mov_b32 s15, 0x20000
    s_mov_b32 s16, s6
    s_mov_b32 s17, s7
    s_mov_b32 s18, 0x258000
    s_mov_b32 s19, 0x20000
    s_mov_b32 s28, s8
    s_mov_b32 s29, s9
    s_mov_b32 s30, 0x100
    s_mov_b32 s31, 0x20000
    s_mov_b32 s40, s10
    s_mov_b32 s41, s11
    s_mov_b32 s42, 0x10000
    s_mov_b32 s43, 0x20000
    s_add_u32 m0, s60, s56
    s_nop 0
    buffer_load_dwordx4 v16, s[12:15], s61 offen offset:0 lds
    buffer_load_dwordx4 v17, s[12:15], s61 offen offset:1024 lds
    s_mov_b64 exec, s[70:71]
    buffer_load_dwordx4 v18, s[12:15], s61 offen offset:2048 lds
    s_mov_b64 exec, -1
    s_add_u32 m0, s63, s56
    s_nop 0
    buffer_load_dwordx4 v20, s[16:19], s62 offen offset:0 lds
    buffer_load_dwordx4 v21, s[16:19], s62 offen offset:1024 lds
    buffer_load_dwordx4 v22, s[16:19], s62 offen offset:2048 lds
    buffer_load_dwordx4 v23, s[16:19], s62 offen offset:3072 lds
    s_add_u32 m0, m0, 4096
    s_nop 0
    buffer_load_dwordx4 v24, s[16:19], s62 offen offset:0 lds
    s_add_u32 s38, s38, 1
    s_cmp_eq_u32 s38, 10
    s_cselect_b32 s39, 1280, 0
    s_cselect_b32 s26, 2457600, 0
    s_cselect_b32 s38, 0, s38
    s_sub_u32 s61, s61, s39
    s_sub_u32 s62, s62, s26
    s_add_u32 s61, s61, 128
    s_add_u32 s62, s62, 245760
    s_add_u32 s56, s56, 32768
    s_and_b32 s56, s56, 0x1ffff
    s_add_u32 m0, s60, s56
    s_nop 0
    buffer_load_dwordx4 v16, s[12:15], s61 offen offset:0 lds
    buffer_load_dwordx4 v17, s[12:15], s61 offen offset:1024 lds
    s_mov_b64 exec, s[70:71]
    buffer_load_dwordx4 v18, s[12:15], s61 offen offset:2048 lds
    s_mov_b64 exec, -1
    s_add_u32 m0, s63, s56
    s_nop 0
    buffer_load_dwordx4 v20, s[16:19], s62 offen offset:0 lds
    buffer_load_dwordx4 v21, s[16:19], s62 offen offset:1024 lds
    buffer_load_dwordx4 v22, s[16:19], s62 offen offset:2048 lds
    buffer_load_dwordx4 v23, s[16:19], s62 offen offset:3072 lds
    s_add_u32 m0, m0, 4096
    s_nop 0
    buffer_load_dwordx4 v24, s[16:19], s62 offen offset:0 lds
    s_add_u32 s38, s38, 1
    s_cmp_eq_u32 s38, 10
    s_cselect_b32 s39, 1280, 0
    s_cselect_b32 s26, 2457600, 0
    s_cselect_b32 s38, 0, s38
    s_sub_u32 s61, s61, s39
    s_sub_u32 s62, s62, s26
    s_add_u32 s61, s61, 128
    s_add_u32 s62, s62, 245760
    s_add_u32 s56, s56, 32768
    s_and_b32 s56, s56, 0x1ffff
    v_lshlrev_b32 v26, 4, v3
    v_add_u32 v26, 12160, v26
    s_cmp_lg_u32 s37, 3
    s_cbranch_scc1 P1_NOONES
    s_mov_b64 exec, 0xff
    ds_write_b128 v26, v[12:15] offset:0
    ds_write_b128 v26, v[12:15] offset:32768
    v_add_u32 v26, 0x10000, v26
    ds_write_b128 v26, v[12:15] offset:0
    ds_write_b128 v26, v[12:15] offset:32768
    s_mov_b64 exec, -1
P1_NOONES:
    s_and_b32 s44, s2, 7
    s_mul_i32 s44, s44, 22
    s_lshr_b32 s45, s2, 3
    s_add_u32 s44, s44, s45
    s_lshl_b32 s44, s44, 2
    s_add_u32 s44, s44, s37
    s_min_u32 s72, s44, 579
    s_mov_b32 s27, s44
    s_cmp_ge_u32 s72, 240
    s_cbranch_scc1 P1_SW2_0
    s_mul_i32 s44, s72, 0x1556
    s_lshr_b32 s44, s44, 16
    s_mul_i32 s75, s44, 12
    s_sub_u32 s75, s72, s75
    s_mul_i32 s76, s75, 160
    s_add_u32 s76, s76, s44
    s_lshl_b32 s76, s76, 10
    s_add_u32 s76, s76, 851968
    s_mov_b32 s77, 20480
    s_lshl_b32 s44, s44, 5
    s_mov_b32 s45, 3072
    s_mov_b32 s46, 16
    s_mov_b32 s47, 4
    s_mov_b32 s74, 1
    s_mov_b32 s4, s22
    s_mov_b32 s5, s23
    s_mov_b32 s6, 1966080
    s_branch P1_SD_0
P1_SW2_0:
    s_cmp_ge_u32 s72, 480
    s_cbranch_scc1 P1_SWO_0
    s_sub_u32 s47, s72, 240
    s_mul_i32 s44, s47, 0x3334
    s_lshr_b32 s44, s44, 16
    s_mul_i32 s75, s44, 5
    s_sub_u32 s75, s47, s75
    s_mul_i32 s76, s75, 384
    s_add_u32 s76, s76, s44
    s_lshl_b32 s76, s76, 10
    s_add_u32 s76, s76, 2818048
    s_mov_b32 s77, 49152
    s_lshl_b32 s44, s44, 5
    s_mov_b32 s45, 1280
    s_mov_b32 s46, 16
    s_mov_b32 s47, 4
    s_mov_b32 s74, 1
    s_mov_b32 s4, s24
    s_mov_b32 s5, s25
    s_mov_b32 s6, 1966080
    s_branch P1_SD_0
P1_SWO_0:
    s_sub_u32 s47, s72, 480
    s_mul_i32 s44, s47, 0x3334
    s_lshr_b32 s44, s44, 16
    s_mul_i32 s75, s44, 5
    s_sub_u32 s75, s47, s75
    s_mul_i32 s76, s75, 160
    s_add_u32 s76, s76, s44
    s_lshl_b32 s76, s76, 10
    s_mov_b32 s77, 20480
    s_mul_i32 s46, s44, 0x3334
    s_lshr_b32 s46, s46, 16
    s_mul_i32 s47, s46, 5
    s_sub_u32 s47, s44, s47
    s_mul_i32 s44, s46, 160
    s_mul_i32 s45, s47, 40
    s_cmp_eq_u32 s47, 4
    s_cselect_b32 s45, 16, s45
    s_add_u32 s44, s44, s45
    s_cmp_eq_u32 s47, 4
    s_cselect_b32 s46, 80, 20
    s_cselect_b32 s74, 20, 1
    s_cselect_b32 s47, 1, 4
    s_mov_b32 s45, 1280
    s_mov_b32 s4, s20
    s_mov_b32 s5, s21
    s_mov_b32 s6, 819200
P1_SD_0:
    s_mov_b32 s7, 0x20000
    s_mul_i32 s74, s74, s45
    v_mul_lo_u32 v26, v5, s74
    v_or_b32 v27, 0, v5
    v_lshlrev_b32 v27, 1, v27
    v_xor_b32 v27, v27, v4
    v_lshl_add_u32 v240, v27, 4, v26
    v_or_b32 v27, 4, v5
    v_lshlrev_b32 v27, 1, v27
    v_xor_b32 v27, v27, v4
    v_lshl_add_u32 v241, v27, 4, v26
    s_mul_i32 s44, s44, s45
    s_lshl_b32 s75, s75, 8
    s_add_u32 s78, s44, s75
    s_mul_i32 s79, s46, s45
    s_mul_i32 s80, s47, s45
    s_mul_i32 s44, s35, 95
    v_and_b32 v248, 31, v3
    v_lshlrev_b32 v248, 2, v248
    v_and_b32 v26, 31, v3
    s_lshl_b32 s45, s37, 5
    v_add_u32 v26, s45, v26
    v_lshlrev_b32 v246, 3, v26
    s_lshl_b32 s87, s44, 3
    s_sub_u32 s45, 2048, s44
    s_min_u32 s45, s45, 95
    v_cmp_gt_u32 s[46:47], s45, v26
    s_add_u32 s48, s10, 0x34000
    s_addc_u32 s49, s11, 0
    s_mov_b32 s50, 0x4000
    s_mov_b32 s51, 0x20000
    s_waitcnt vmcnt(8)
    s_barrier
    s_add_u32 m0, s60, s56
    s_nop 0
    buffer_load_dwordx4 v16, s[12:15], s61 offen offset:0 lds
    buffer_load_dwordx4 v17, s[12:15], s61 offen offset:1024 lds
    s_mov_b64 exec, s[70:71]
    buffer_load_dwordx4 v18, s[12:15], s61 offen offset:2048 lds
    s_mov_b64 exec, -1
    s_add_u32 m0, s63, s56
    s_nop 0
    buffer_load_dwordx4 v20, s[16:19], s62 offen offset:0 lds
    buffer_load_dwordx4 v21, s[16:19], s62 offen offset:1024 lds
    buffer_load_dwordx4 v22, s[16:19], s62 offen offset:2048 lds
    buffer_load_dwordx4 v23, s[16:19], s62 offen offset:3072 lds
    s_add_u32 m0, m0, 4096
    s_nop 0
    buffer_load_dwordx4 v24, s[16:19], s62 offen offset:0 lds
    s_add_u32 s38, s38, 1
    s_cmp_eq_u32 s38, 10
    s_cselect_b32 s39, 1280, 0
    s_cselect_b32 s26, 2457600, 0
    s_cselect_b32 s38, 0, s38
    s_sub_u32 s61, s61, s39
    s_sub_u32 s62, s62, s26
    s_add_u32 s61, s61, 128
    s_add_u32 s62, s62, 245760
    s_add_u32 s56, s56, 32768
    s_and_b32 s56, s56, 0x1ffff
    v_lshrrev_b32 v26, 5, v3
    v_mul_u32_u24 v26, 1280, v26
    v_and_b32 v27, 31, v3
    v_lshl_add_u32 v26, v27, 3, v26
    s_lshl_b32 s44, s2, 3
    s_lshl_b32 s45, s37, 1
    s_add_u32 s44, s44, s45
    s_mul_i32 s45, s44, 1280
    buffer_load_dwordx2 v[40:41], v26, s[12:15], s45 offen offset:0
    buffer_load_dwordx2 v[42:43], v26, s[12:15], s45 offen offset:256
    buffer_load_dwordx2 v[44:45], v26, s[12:15], s45 offen offset:512
    buffer_load_dwordx2 v[46:47], v26, s[12:15], s45 offen offset:768
    buffer_load_dwordx2 v[48:49], v26, s[12:15], s45 offen offset:1024
    s_add_u32 m0, s60, s56
    s_nop 0
    buffer_load_dwordx4 v16, s[12:15], s61 offen offset:0 lds
    buffer_load_dwordx4 v17, s[12:15], s61 offen offset:1024 lds
    s_mov_b64 exec, s[70:71]
    buffer_load_dwordx4 v18, s[12:15], s61 offen offset:2048 lds
    s_mov_b64 exec, -1
    s_add_u32 m0, s63, s56
    s_nop 0
    buffer_load_dwordx4 v20, s[16:19], s62 offen offset:0 lds
    buffer_load_dwordx4 v21, s[16:19], s62 offen offset:1024 lds
    buffer_load_dwordx4 v22, s[16:19], s62 offen offset:2048 lds
    buffer_load_dwordx4 v23, s[16:19], s62 offen offset:3072 lds
    s_add_u32 m0, m0, 4096
    s_nop 0
    buffer_load_dwordx4 v24, s[16:19], s62 offen offset:0 lds
    s_add_u32 s38, s38, 1
    s_cmp_eq_u32 s38, 10
    s_cselect_b32 s39, 1280, 0
    s_cselect_b32 s26, 2457600, 0
    s_cselect_b32 s38, 0, s38
    s_sub_u32 s61, s61, s39
    s_sub_u32 s62, s62, s26
    s_add_u32 s61, s61, 128
    s_add_u32 s62, s62, 245760
    s_add_u32 s56, s56, 32768
    s_and_b32 s56, s56, 0x1ffff
    s_waitcnt vmcnt(21)
    s_barrier
    s_add_u32 m0, s60, s56
    s_nop 0
    buffer_load_dwordx4 v16, s[12:15], s61 offen offset:0 lds
    buffer_load_dwordx4 v17, s[12:15], s61 offen offset:1024 lds
    s_mov_b64 exec, s[70:71]
    buffer_load_dwordx4 v18, s[12:15], s61 offen offset:2048 lds
    s_mov_b64 exec, -1
    s_add_u32 m0, s63, s56
    s_nop 0
    buffer_load_dwordx4 v20, s[16:19], s62 offen offset:0 lds
    buffer_load_dwordx4 v21, s[16:19], s62 offen offset:1024 lds
    buffer_load_dwordx4 v22, s[16:19], s62 offen offset:2048 lds
    buffer_load_dwordx4 v23, s[16:19], s62 offen offset:3072 lds
    s_add_u32 m0, m0, 4096
    s_nop 0
    buffer_load_dwordx4 v24, s[16:19], s62 offen offset:0 lds
    s_add_u32 s38, s38, 1
    s_cmp_eq_u32 s38, 10
    s_cselect_b32 s39, 1280, 0
    s_cselect_b32 s26, 2457600, 0
    s_cselect_b32 s38, 0, s38
    s_sub_u32 s61, s61, s39
    s_sub_u32 s62, s62, s26
    s_add_u32 s61, s61, 128
    s_add_u32 s62, s62, 245760
    s_add_u32 s56, s56, 32768
    s_and_b32 s56, s56, 0x1ffff
    s_waitcnt vmcnt(16)
    v_mov_b32 v60, 0
    v_mov_b32 v61, 0
    v_mov_b32 v62, 0
    v_mov_b32 v63, 0
    v_lshlrev_b32 v64, 16, v40
    v_and_b32 v65, 0xffff0000, v40
    v_add_f32 v60, v60, v64
    v_add_f32 v61, v61, v65
    v_fma_f32 v62, v64, v64, v62
    v_fma_f32 v63, v65, v65, v63
    v_lshlrev_b32 v66, 16, v41
    v_and_b32 v67, 0xffff0000, v41
    v_add_f32 v60, v60, v66
    v_add_f32 v61, v61, v67
    v_fma_f32 v62, v66, v66, v62
    v_fma_f32 v63, v67, v67, v63
    v_lshlrev_b32 v64, 16, v42
    v_and_b32 v65, 0xffff0000, v42
    v_add_f32 v60, v60, v64
    v_add_f32 v61, v61, v65
    v_fma_f32 v62, v64, v64, v62
    v_fma_f32 v63, v65, v65, v63
    v_lshlrev_b32 v66, 16, v43
    v_and_b32 v67, 0xffff0000, v43
    v_add_f32 v60, v60, v66
    v_add_f32 v61, v61, v67
    v_fma_f32 v62, v66, v66, v62
    v_fma_f32 v63, v67, v67, v63
    v_lshlrev_b32 v64, 16, v44
    v_and_b32 v65, 0xffff0000, v44
    v_add_f32 v60, v60, v64
    v_add_f32 v61, v61, v65
    v_fma_f32 v62, v64, v64, v62
    v_fma_f32 v63, v65, v65, v63
    v_lshlrev_b32 v66, 16, v45
    v_and_b32 v67, 0xffff0000, v45
    v_add_f32 v60, v60, v66
    v_add_f32 v61, v61, v67
    v_fma_f32 v62, v66, v66, v62
    v_fma_f32 v63, v67, v67, v63
    v_lshlrev_b32 v64, 16, v46
    v_and_b32 v65, 0xffff0000, v46
    v_add_f32 v60, v60, v64
    v_add_f32 v61, v61, v65
    v_fma_f32 v62, v64, v64, v62
    v_fma_f32 v63, v65, v65, v63
    v_lshlrev_b32 v66, 16, v47
    v_and_b32 v67, 0xffff0000, v47
    v_add_f32 v60, v60, v66
    v_add_f32 v61, v61, v67
    v_fma_f32 v62, v66, v66, v62
    v_fma_f32 v63, v67, v67, v63
    v_lshlrev_b32 v64, 16, v48
    v_and_b32 v65, 0xffff0000, v48
    v_add_f32 v60, v60, v64
    v_add_f32 v61, v61, v65
    v_fma_f32 v62, v64, v64, v62
    v_fma_f32 v63, v65, v65, v63
    v_lshlrev_b32 v66, 16, v49
    v_and_b32 v67, 0xffff0000, v49
    v_add_f32 v60, v60, v66
    v_add_f32 v61, v61, v67
    v_fma_f32 v62, v66, v66, v62
    v_fma_f32 v63, v67, v67, v63
    v_add_f32 v60, v60, v61
    v_add_f32 v62, v62, v63
    s_nop 0
    v_add_f32_dpp v60, v60, v60 quad_perm:[1,0,3,2] row_mask:0xf bank_mask:0xf
    s_nop 1
    v_add_f32_dpp v60, v60, v60 quad_perm:[2,3,0,1] row_mask:0xf bank_mask:0xf
    s_nop 1
    v_add_f32_dpp v60, v60, v60 row_half_mirror row_mask:0xf bank_mask:0xf
    s_nop 1
    v_add_f32_dpp v60, v60, v60 row_mirror row_mask:0xf bank_mask:0xf
    v_mov_b32 v64, v60
    s_nop 1
    v_permlane16_swap_b32 v60, v64
    v_add_f32 v60, v60, v64
    v_add_f32_dpp v62, v62, v62 quad_perm:[1,0,3,2] row_mask:0xf bank_mask:0xf
    s_nop 1
    v_add_f32_dpp v62, v62, v62 quad_perm:[2,3,0,1] row_mask:0xf bank_mask:0xf
    s_nop 1
    v_add_f32_dpp v62, v62, v62 row_half_mirror row_mask:0xf bank_mask:0xf
    s_nop 1
    v_add_f32_dpp v62, v62, v62 row_mirror row_mask:0xf bank_mask:0xf
    v_mov_b32 v64, v62
    s_nop 1
    v_permlane16_swap_b32 v62, v64
    v_add_f32 v62, v62, v64
    s_mov_b32 s64, 0x3acccccd
    s_mov_b32 s65, 0x3727c5ac
    v_mul_f32 v60, s64, v60
    v_mul_f32 v62, s64, v62
    v_fma_f32 v62, -v60, v60, v62
    v_max_f32 v62, 0, v62
    v_add_f32 v62, s65, v62
    v_rsq_f32 v62, v62
    s_nop 0
    v_mul_f32 v63, v60, v62
    v_max_f32 v62, 0x00800000, v62
    v_lshrrev_b32 v64, 5, v3
    v_lshlrev_b32 v64, 3, v64
    s_lshl_b32 s44, s2, 3
    s_lshl_b32 s45, s37, 1
    s_add_u32 s44, s44, s45
    s_lshl_b32 s86, s44, 3
    buffer_load_dword v249, v248, s[28:31], 0 offen sc1
    s_waitcnt vmcnt(22)
    s_barrier
    s_add_u32 m0, s60, s56
    s_nop 0
    buffer_load_dwordx4 v16, s[12:15], s61 offen offset:0 lds
    buffer_load_dwordx4 v17, s[12:15], s61 offen offset:1024 lds
    s_mov_b64 exec, s[70:71]
    buffer_load_dwordx4 v18, s[12:15], s61 offen offset:2048 lds
    s_mov_b64 exec, -1
    s_add_u32 m0, s63, s56
    s_nop 0
    buffer_load_dwordx4 v20, s[16:19], s62 offen offset:0 lds
    buffer_load_dwordx4 v21, s[16:19], s62 offen offset:1024 lds
    buffer_load_dwordx4 v22, s[16:19], s62 offen offset:2048 lds
    buffer_load_dwordx4 v23, s[16:19], s62 offen offset:3072 lds
    s_add_u32 m0, m0, 4096
    s_nop 0
    buffer_load_dwordx4 v24, s[16:19], s62 offen offset:0 lds
    s_add_u32 s38, s38, 1
    s_cmp_eq_u32 s38, 10
    s_cselect_b32 s39, 1280, 0
    s_cselect_b32 s26, 2457600, 0
    s_cselect_b32 s38, 0, s38
    s_sub_u32 s61, s61, s39
    s_sub_u32 s62, s62, s26
    s_add_u32 s61, s61, 128
    s_add_u32 s62, s62, 245760
    s_add_u32 s56, s56, 32768
    s_and_b32 s56, s56, 0x1ffff
    s_waitcnt vmcnt(17)
    s_barrier
    s_add_u32 m0, s60, s56
    s_nop 0
    buffer_load_dwordx4 v16, s[12:15], s61 offen offset:0 lds
    buffer_load_dwordx4 v17, s[12:15], s61 offen offset:1024 lds
    s_mov_b64 exec, s[70:71]
    buffer_load_dwordx4 v18, s[12:15], s61 offen offset:2048 lds
    s_mov_b64 exec, -1
    s_add_u32 m0, s63, s56
    s_nop 0
    buffer_load_dwordx4 v20, s[16:19], s62 offen offset:0 lds
    buffer_load_dwordx4 v21, s[16:19], s62 offen offset:1024 lds
    buffer_load_dwordx4 v22, s[16:19], s62 offen offset:2048 lds
    buffer_load_dwordx4 v23, s[16:19], s62 offen offset:3072 lds
    s_add_u32 m0, m0, 4096
    s_nop 0
    buffer_load_dwordx4 v24, s[16:19], s62 offen offset:0 lds
    s_add_u32 s38, s38, 1
    s_cmp_eq_u32 s38, 10
    s_cselect_b32 s39, 1280, 0
    s_cselect_b32 s26, 2457600, 0
    s_cselect_b32 s38, 0, s38
    s_sub_u32 s61, s61, s39
    s_sub_u32 s62, s62, s26
    s_add_u32 s61, s61, 128
    s_add_u32 s62, s62, 245760
    s_add_u32 s56, s56, 32768
    s_and_b32 s56, s56, 0x1ffff
    s_waitcnt vmcnt(17)
    s_barrier
    s_add_u32 m0, s60, s56
    s_nop 0
    buffer_load_dwordx4 v16, s[12:15], s61 offen offset:0 lds
    buffer_load_dwordx4 v17, s[12:15], s61 offen offset:1024 lds
    s_mov_b64 exec, s[70:71]
    buffer_load_dwordx4 v18, s[12:15], s61 offen offset:2048 lds
    s_mov_b64 exec, -1
    s_add_u32 m0, s63, s56
    s_nop 0
    buffer_load_dwordx4 v20, s[16:19], s62 offen offset:0 lds
    buffer_load_dwordx4 v21, s[16:19], s62 offen offset:1024 lds
    buffer_load_dwordx4 v22, s[16:19], s62 offen offset:2048 lds
    buffer_load_dwordx4 v23, s[16:19], s62 offen offset:3072 lds
    s_add_u32 m0, m0, 4096
    s_nop 0
    buffer_load_dwordx4 v24, s[16:19], s62 offen offset:0 lds
    s_add_u32 s38, s38, 1
    s_cmp_eq_u32 s38, 10
    s_cselect_b32 s39, 1280, 0
    s_cselect_b32 s26, 2457600, 0
    s_cselect_b32 s38, 0, s38
    s_sub_u32 s61, s61, s39
    s_sub_u32 s62, s62, s26
    s_add_u32 s61, s61, 128
    s_add_u32 s62, s62, 245760
    s_add_u32 s56, s56, 32768
    s_and_b32 s56, s56, 0x1ffff
    s_waitcnt vmcnt(24)
    s_mov_b32 s74, 0
P1_WZ_KV:
    v_cmp_ne_u32 vcc, 1, v249
    s_add_u32 s74, s74, 1
    s_cbranch_vccz P1_WZD_KV
    s_cmp_gt_u32 s74, 400000
    s_cbranch_scc1 P1_WZD_KV
    buffer_load_dword v249, v248, s[28:31], 0 offen sc1
    s_waitcnt vmcnt(0)
    s_branch P1_WZ_KV
P1_WZD_KV:
    buffer_store_dwordx2 v[62:63], v64, s[48:51], s86 offen sc1
    s_waitcnt vmcnt(17)
    s_barrier
    s_add_u32 m0, s60, s56
    s_nop 0
    buffer_load_dwordx4 v16, s[12:15], s61 offen offset:0 lds
    buffer_load_dwordx4 v17, s[12:15], s61 offen offset:1024 lds
    s_mov_b64 exec, s[70:71]
    buffer_load_dwordx4 v18, s[12:15], s61 offen offset:2048 lds
    s_mov_b64 exec, -1
    s_add_u32 m0, s63, s56
    s_nop 0
    buffer_load_dwordx4 v20, s[16:19], s62 offen offset:0 lds
    buffer_load_dwordx4 v21, s[16:19], s62 offen offset:1024 lds
    buffer_load_dwordx4 v22, s[16:19], s62 offen offset:2048 lds
    buffer_load_dwordx4 v23, s[16:19], s62 offen offset:3072 lds
    s_add_u32 m0, m0, 4096
    s_nop 0
    buffer_load_dwordx4 v24, s[16:19], s62 offen offset:0 lds
    s_add_u32 s38, s38, 1
    s_cmp_eq_u32 s38, 10
    s_cselect_b32 s39, 1280, 0
    s_cselect_b32 s26, 2457600, 0
    s_cselect_b32 s38, 0, s38
    s_sub_u32 s61, s61, s39
    s_sub_u32 s62, s62, s26
    s_add_u32 s61, s61, 128
    s_add_u32 s62, s62, 245760
    s_add_u32 s56, s56, 32768
    s_and_b32 s56, s56, 0x1ffff
    s_waitcnt vmcnt(17)
    s_barrier
    s_add_u32 m0, s60, s56
    s_nop 0
    buffer_load_dwordx4 v16, s[12:15], s61 offen offset:0 lds
    buffer_load_dwordx4 v17, s[12:15], s61 offen offset:1024 lds
    s_mov_b64 exec, s[70:71]
    buffer_load_dwordx4 v18, s[12:15], s61 offen offset:2048 lds
    s_mov_b64 exec, -1
    s_add_u32 m0, s63, s56
    s_nop 0
    buffer_load_dwordx4 v20, s[16:19], s62 offen offset:0 lds
    buffer_load_dwordx4 v21, s[16:19], s62 offen offset:1024 lds
    buffer_load_dwordx4 v22, s[16:19], s62 offen offset:2048 lds
    buffer_load_dwordx4 v23, s[16:19], s62 offen offset:3072 lds
    s_add_u32 m0, m0, 4096
    s_nop 0
    buffer_load_dwordx4 v24, s[16:19], s62 offen offset:0 lds
    s_add_u32 s38, s38, 1
    s_cmp_eq_u32 s38, 10
    s_cselect_b32 s39, 1280, 0
    s_cselect_b32 s26, 2457600, 0
    s_cselect_b32 s38, 0, s38
    s_sub_u32 s61, s61, s39
    s_sub_u32 s62, s62, s26
    s_add_u32 s61, s61, 128
    s_add_u32 s62, s62, 245760
    s_add_u32 s56, s56, 32768
    s_and_b32 s56, s56, 0x1ffff
    s_waitcnt vmcnt(17)
    s_barrier
    buffer_load_dwordx2 v[60:61], v246, s[48:51], s87 offen sc1
    s_lshl_b32 s75, s37, 13
    s_add_u32 m0, s75, 131072
    s_mul_i32 s74, s80, 0
    s_add_u32 s74, s74, s78
    buffer_load_dwordx4 v240, s[4:7], s74 offen lds
    s_add_u32 m0, m0, 1024
    s_mul_i32 s74, s80, 1
    s_add_u32 s74, s74, s78
    buffer_load_dwordx4 v241, s[4:7], s74 offen lds
    s_add_u32 m0, m0, 1024
    s_mul_i32 s74, s80, 2
    s_add_u32 s74, s74, s78
    buffer_load_dwordx4 v240, s[4:7], s74 offen lds
    s_add_u32 m0, m0, 1024
    s_mul_i32 s74, s80, 3
    s_add_u32 s74, s74, s78
    buffer_load_dwordx4 v241, s[4:7], s74 offen lds
    s_add_u32 m0, m0, 1024
    s_mul_i32 s74, s80, 0
    s_add_u32 s74, s74, s78
    s_add_u32 s74, s74, s79
    buffer_load_dwordx4 v240, s[4:7], s74 offen lds
    s_add_u32 m0, m0, 1024
    s_mul_i32 s74, s80, 1
    s_add_u32 s74, s74, s78
    s_add_u32 s74, s74, s79
    buffer_load_dwordx4 v241, s[4:7], s74 offen lds
    s_add_u32 m0, m0, 1024
    s_mul_i32 s74, s80, 2
    s_add_u32 s74, s74, s78
    s_add_u32 s74, s74, s79
    buffer_load_dwordx4 v240, s[4:7], s74 offen lds
    s_add_u32 m0, m0, 1024
    s_mul_i32 s74, s80, 3
    s_add_u32 s74, s74, s78
    s_add_u32 s74, s74, s79
    buffer_load_dwordx4 v241, s[4:7], s74 offen lds
    s_waitcnt vmcnt(17)
    s_barrier
    s_waitcnt vmcnt(9)
    s_barrier
    s_waitcnt vmcnt(8)
    s_mov_b32 s74, 0
P1_FS_KV:
    v_cmp_eq_u32 vcc, 0, v60
    s_nop 3
    s_and_b64 vcc, vcc, s[46:47]
    s_add_u32 s74, s74, 1
    s_cbranch_vccz P1_FSD_KV
    s_cmp_gt_u32 s74, 400000
    s_cbranch_scc1 P1_FSD_KV
    buffer_load_dwordx2 v[60:61], v246, s[48:51], s87 offen sc1
    s_waitcnt vmcnt(0)
    s_branch P1_FS_KV
P1_FSD_KV:
    v_add_u32 v27, 65536, v246
    ds_write_b64 v27, v[60:61]
    s_barrier
    s_waitcnt lgkmcnt(0)
    s_barrier
    s_cmp_ge_u32 s27, 580
    s_cbranch_scc1 P1_NOSIDE
    s_add_u32 s48, s10, 0xb40000
    s_addc_u32 s49, s11, 0
    s_mov_b32 s50, 0x490000
    s_mov_b32 s51, 0x20000
    s_waitcnt vmcnt(0)
    v_lshl_add_u32 v26, v5, 2, v6
    v_and_b32 v27, 7, v26
    v_lshlrev_b32 v26, 8, v26
    v_lshl_add_u32 v26, v7, 3, v26
    v_lshl_add_u32 v26, v27, 5, v26
    s_lshl_b32 s75, s37, 13
    s_add_u32 s75, s75, 131072
    v_add_u32 v26, s75, v26
    v_xor_b32 v27, 0, v26
    ds_read_b64_tr_b16 v[100:101], v27
    ds_read_b64_tr_b16 v[102:103], v27 offset:4096
    v_xor_b32 v27, 32, v26
    ds_read_b64_tr_b16 v[104:105], v27
    ds_read_b64_tr_b16 v[106:107], v27 offset:4096
    v_xor_b32 v27, 64, v26
    ds_read_b64_tr_b16 v[108:109], v27
    ds_read_b64_tr_b16 v[110:111], v27 offset:4096
    v_xor_b32 v27, 96, v26
    ds_read_b64_tr_b16 v[112:113], v27
    ds_read_b64_tr_b16 v[114:115], v27 offset:4096
    v_xor_b32 v27, 128, v26
    ds_read_b64_tr_b16 v[116:117], v27
    ds_read_b64_tr_b16 v[118:119], v27 offset:4096
    v_xor_b32 v27, 160, v26
    ds_read_b64_tr_b16 v[120:121], v27
    ds_read_b64_tr_b16 v[122:123], v27 offset:4096
    v_xor_b32 v27, 192, v26
    ds_read_b64_tr_b16 v[124:125], v27
    ds_read_b64_tr_b16 v[126:127], v27 offset:4096
    v_xor_b32 v27, 224, v26
    ds_read_b64_tr_b16 v[128:129], v27
    ds_read_b64_tr_b16 v[130:131], v27 offset:4096
    s_waitcnt lgkmcnt(0)
    s_mov_b32 s75, s76
    buffer_store_dwordx4 v[100:103], v1, s[48:51], s75 offen sc1
    s_add_u32 s75, s75, s77
    buffer_store_dwordx4 v[104:107], v1, s[48:51], s75 offen sc1
    s_add_u32 s75, s75, s77
    buffer_store_dwordx4 v[108:111], v1, s[48:51], s75 offen sc1
    s_add_u32 s75, s75, s77
    buffer_store_dwordx4 v[112:115], v1, s[48:51], s75 offen sc1
    s_add_u32 s75, s75, s77
    buffer_store_dwordx4 v[116:119], v1, s[48:51], s75 offen sc1
    s_add_u32 s75, s75, s77
    buffer_store_dwordx4 v[120:123], v1, s[48:51], s75 offen sc1
    s_add_u32 s75, s75, s77
    buffer_store_dwordx4 v[124:127], v1, s[48:51], s75 offen sc1
    s_add_u32 s75, s75, s77
    buffer_store_dwordx4 v[128:131], v1, s[48:51], s75 offen sc1
    v_mfma_f32_16x16x32_bf16 v[140:143], v[12:15], v[100:103], 0
    v_mfma_f32_16x16x32_bf16 v[144:147], v[12:15], v[104:107], 0
    v_mfma_f32_16x16x32_bf16 v[148:151], v[12:15], v[108:111], 0
    v_mfma_f32_16x16x32_bf16 v[152:155], v[12:15], v[112:115], 0
    v_mfma_f32_16x16x32_bf16 v[156:159], v[12:15], v[116:119], 0
    v_mfma_f32_16x16x32_bf16 v[160:163], v[12:15], v[120:123], 0
    v_mfma_f32_16x16x32_bf16 v[164:167], v[12:15], v[124:127], 0
    v_mfma_f32_16x16x32_bf16 v[168:171], v[12:15], v[128:131], 0
    s_nop 0
    v_mov_b32 v244, v140
    v_cmp_eq_u32 vcc, 1, v5
    s_nop 1
    v_cndmask_b32 v244, v244, v144, vcc
    v_cmp_eq_u32 vcc, 2, v5
    s_nop 1
    v_cndmask_b32 v244, v244, v148, vcc
    v_cmp_eq_u32 vcc, 3, v5
    s_nop 1
    v_cndmask_b32 v244, v244, v152, vcc
    v_mov_b32 v245, v156
    v_cmp_eq_u32 vcc, 1, v5
    s_nop 1
    v_cndmask_b32 v245, v245, v160, vcc
    v_cmp_eq_u32 vcc, 2, v5
    s_nop 1
    v_cndmask_b32 v245, v245, v164, vcc
    v_cmp_eq_u32 vcc, 3, v5
    s_nop 1
    v_cndmask_b32 v245, v245, v168, vcc
    v_mov_b32 v240, v244
    v_mov_b32 v241, v245
    s_cmp_ge_u32 s72, 240
    s_cbranch_scc1 P1_NOSIDE
    s_mul_i32 s44, s72, 0x1556
    s_lshr_b32 s44, s44, 16
    s_mul_i32 s44, s44, 12
    s_sub_u32 s44, s72, s44
    s_lshl_b32 s44, s44, 9
    s_add_u32 s44, s44, 57344
    v_lshlrev_b32 v26, 2, v3
    buffer_atomic_add_f32 v240, v26, s[40:43], s44 offen
    buffer_atomic_add_f32 v241, v26, s[40:43], s44 offen offset:256
P1_NOSIDE:
    s_barrier
    s_endpgm
P1_KVC:
    s_waitcnt lgkmcnt(0)
    s_mov_b32 s28, s8
    s_mov_b32 s29, s9
    s_mov_b32 s30, 0x100
    s_mov_b32 s31, 0x20000
    s_mov_b32 s40, s10
    s_mov_b32 s41, s11
    s_mov_b32 s42, 0x10000
    s_mov_b32 s43, 0x20000
    s_cmp_ge_u32 s2, 8
    s_cbranch_scc1 P1_NOZERO_KV
    s_add_u32 s48, s10, 0x34000
    s_addc_u32 s49, s11, 0
    s_mov_b32 s50, 0xa000
    s_mov_b32 s51, 0x20000
    v_mov_b32 v28, 0
    v_mov_b32 v29, 0
    v_mov_b32 v30, 0
    v_mov_b32 v31, 0
    s_lshl_b32 s44, s2, 2
    s_add_u32 s44, s44, s37
    s_lshl_b32 s44, s44, 10
    s_add_u32 s45, s44, 32768
    buffer_store_dwordx4 v[28:31], v1, s[40:43], s44 offen sc1
    buffer_store_dwordx4 v[28:31], v1, s[40:43], s45 offen sc1
    buffer_store_dwordx4 v[28:31], v1, s[48:51], s44 offen sc1
    buffer_store_dwordx4 v[28:31], v1, s[48:51], s45 offen sc1
P1_NOZERO_KV:
    s_mov_b32 s66, 0x358637bd
    s_mov_b32 s67, 0x358637bd
    s_mov_b32 s68, 0x3fb8aa3b
    s_mov_b32 s69, 0x3fb8aa3b
    v_mov_b32 v250, 0xb5c1a2a0
    v_mov_b32 v251, 0xb5c1a2a0
    v_and_b32 v26, 7, v4
    v_xor_b32 v26, v26, v5
    v_lshlrev_b32 v26, 4, v26
    v_lshl_add_u32 v26, v4, 7, v26
    s_mul_i32 s44, s38, 6144
    v_add_u32 v32, s44, v26
    v_xor_b32 v33, 64, v32
    v_lshl_add_u32 v26, v5, 3, v6
    v_mul_u32_u24 v26, 320, v26
    v_and_b32 v27, 1, v5
    v_lshlrev_b32 v27, 5, v27
    s_mul_i32 s44, s39, 10
    v_add_u32 v28, 0, v7
    v_cmp_le_u32 vcc, 10, v28
    v_add_u32 v28, s44, v28
    v_subrev_u32 v29, 10, v28
    v_cndmask_b32 v28, v28, v29, vcc
    v_lshrrev_b32 v29, 1, v28
    v_add_u32 v30, 10, v29
    v_cndmask_b32 v29, v29, v30, vcc
    v_lshlrev_b32 v29, 4, v29
    v_xor_b32 v29, v29, v27
    v_and_b32 v28, 1, v28
    v_lshl_add_u32 v29, v28, 3, v29
    v_add_u32 v36, v26, v29
    v_add_u32 v28, 0, v5
    v_cmp_le_u32 vcc, 10, v28
    v_add_u32 v28, s44, v28
    v_subrev_u32 v29, 10, v28
    v_cndmask_b32 v28, v28, v29, vcc
    v_lshlrev_b32 v28, 3, v28
    v_add_u32 v29, 160, v28
    v_cndmask_b32 v46, v28, v29, vcc
    v_add_u32 v28, 4, v7
    v_cmp_le_u32 vcc, 10, v28
    v_add_u32 v28, s44, v28
    v_subrev_u32 v29, 10, v28
    v_cndmask_b32 v28, v28, v29, vcc
    v_lshrrev_b32 v29, 1, v28
    v_add_u32 v30, 10, v29
    v_cndmask_b32 v29, v29, v30, vcc
    v_lshlrev_b32 v29, 4, v29
    v_xor_b32 v29, v29, v27
    v_and_b32 v28, 1, v28
    v_lshl_add_u32 v29, v28, 3, v29
    v_add_u32 v37, v26, v29
    v_add_u32 v28, 4, v5
    v_cmp_le_u32 vcc, 10, v28
    v_add_u32 v28, s44, v28
    v_subrev_u32 v29, 10, v28
    v_cndmask_b32 v28, v28, v29, vcc
    v_lshlrev_b32 v28, 3, v28
    v_add_u32 v29, 160, v28
    v_cndmask_b32 v47, v28, v29, vcc
    v_add_u32 v28, 8, v7
    v_cmp_le_u32 vcc, 10, v28
    v_add_u32 v28, s44, v28
    v_subrev_u32 v29, 10, v28
    v_cndmask_b32 v28, v28, v29, vcc
    v_lshrrev_b32 v29, 1, v28
    v_add_u32 v30, 10, v29
    v_cndmask_b32 v29, v29, v30, vcc
    v_lshlrev_b32 v29, 4, v29
    v_xor_b32 v29, v29, v27
    v_and_b32 v28, 1, v28
    v_lshl_add_u32 v29, v28, 3, v29
    v_add_u32 v38, v26, v29
    v_add_u32 v28, 8, v5
    v_cmp_le_u32 vcc, 10, v28
    v_add_u32 v28, s44, v28
    v_subrev_u32 v29, 10, v28
    v_cndmask_b32 v28, v28, v29, vcc
    v_lshlrev_b32 v28, 3, v28
    v_add_u32 v29, 160, v28
    v_cndmask_b32 v48, v28, v29, vcc
    v_add_u32 v28, 12, v7
    v_cmp_le_u32 vcc, 10, v28
    v_add_u32 v28, s44, v28
    v_subrev_u32 v29, 10, v28
    v_cndmask_b32 v28, v28, v29, vcc
    v_lshrrev_b32 v29, 1, v28
    v_add_u32 v30, 10, v29
    v_cndmask_b32 v29, v29, v30, vcc
    v_lshlrev_b32 v29, 4, v29
    v_xor_b32 v29, v29, v27
    v_and_b32 v28, 1, v28
    v_lshl_add_u32 v29, v28, 3, v29
    v_add_u32 v39, v26, v29
    v_add_u32 v28, 12, v5
    v_cmp_le_u32 vcc, 10, v28
    v_add_u32 v28, s44, v28
    v_subrev_u32 v29, 10, v28
    v_cndmask_b32 v28, v28, v29, vcc
    v_lshlrev_b32 v28, 3, v28
    v_add_u32 v29, 160, v28
    v_cndmask_b32 v49, v28, v29, vcc
    v_add_u32 v28, 16, v7
    v_cmp_le_u32 vcc, 10, v28
    v_add_u32 v28, s44, v28
    v_subrev_u32 v29, 10, v28
    v_cndmask_b32 v28, v28, v29, vcc
    v_lshrrev_b32 v29, 1, v28
    v_add_u32 v30, 10, v29
    v_cndmask_b32 v29, v29, v30, vcc
    v_lshlrev_b32 v29, 4, v29
    v_xor_b32 v29, v29, v27
    v_and_b32 v28, 1, v28
    v_lshl_add_u32 v29, v28, 3, v29
    v_add_u32 v40, v26, v29
    v_add_u32 v28, 16, v5
    v_cmp_le_u32 vcc, 10, v28
    v_add_u32 v28, s44, v28
    v_subrev_u32 v29, 10, v28
    v_cndmask_b32 v28, v28, v29, vcc
    v_lshlrev_b32 v28, 3, v28
    v_add_u32 v29, 160, v28
    v_cndmask_b32 v50, v28, v29, vcc
    s_mul_i32 s44, s35, 95
    s_sub_u32 s44, 2048, s44
    s_min_u32 s44, s44, 95
    s_mul_i32 s45, s38, 48
    v_add_u32 v26, s45, v4
    v_cmp_gt_u32 vcc, s44, v26
    s_nop 1
    v_cndmask_b32 v200, 0, -1, vcc
    v_add_u32 v26, s45, v4
    v_add_u32 v26, 16, v26
    v_cmp_gt_u32 vcc, s44, v26
    s_nop 1
    v_cndmask_b32 v201, 0, -1, vcc
    v_add_u32 v26, s45, v4
    v_add_u32 v26, 32, v26
    v_cmp_gt_u32 vcc, s44, v26
    s_nop 1
    v_cndmask_b32 v202, 0, -1, vcc
    s_cmp_ge_u32 s2, 8
    s_cbranch_scc1 P1_NOFLAG_KV
    s_waitcnt vmcnt(0)
    v_mov_b32 v28, 1
    s_lshl_b32 s44, s2, 2
    s_add_u32 s44, s44, s37
    s_lshl_b32 s44, s44, 2
    v_mov_b32 v29, 0
    buffer_store_dword v28, v29, s[28:31], s44 offen sc1
P1_NOFLAG_KV:
    v_mov_b32 v116, 0
    v_mov_b32 v117, 0
    v_mov_b32 v118, 0
    v_mov_b32 v119, 0
    v_mov_b32 v120, 0
    v_mov_b32 v121, 0
    v_mov_b32 v122, 0
    v_mov_b32 v123, 0
    v_mov_b32 v124, 0
    v_mov_b32 v125, 0
    v_mov_b32 v126, 0
    v_mov_b32 v127, 0
    v_mov_b32 v128, 0
    v_mov_b32 v129, 0
    v_mov_b32 v130, 0
    v_mov_b32 v131, 0
    v_mov_b32 v132, 0
    v_mov_b32 v133, 0
    v_mov_b32 v134, 0
    v_mov_b32 v135, 0
    v_mov_b32 v136, 0
    v_mov_b32 v137, 0
    v_mov_b32 v138, 0
    v_mov_b32 v139, 0
    v_mov_b32 v140, 0
    v_mov_b32 v141, 0
    v_mov_b32 v142, 0
    v_mov_b32 v143, 0
    v_mov_b32 v144, 0
    v_mov_b32 v145, 0
    v_mov_b32 v146, 0
    v_mov_b32 v147, 0
    v_mov_b32 v148, 0
    v_mov_b32 v149, 0
    v_mov_b32 v150, 0
    v_mov_b32 v151, 0
    v_mov_b32 v152, 0
    v_mov_b32 v153, 0
    v_mov_b32 v154, 0
    v_mov_b32 v155, 0
    v_mov_b32 v156, 0
    v_mov_b32 v157, 0
    v_mov_b32 v158, 0
    v_mov_b32 v159, 0
    v_mov_b32 v160, 0
    v_mov_b32 v161, 0
    v_mov_b32 v162, 0
    v_mov_b32 v163, 0
    v_mov_b32 v164, 0
    v_mov_b32 v165, 0
    v_mov_b32 v166, 0
    v_mov_b32 v167, 0
    v_mov_b32 v168, 0
    v_mov_b32 v169, 0
    v_mov_b32 v170, 0
    v_mov_b32 v171, 0
    v_mov_b32 v172, 0
    v_mov_b32 v173, 0
    v_mov_b32 v174, 0
    v_mov_b32 v175, 0
    s_mov_b32 s59, 0
    s_barrier
    ds_read_b64_tr_b16 v[76:77], v36 offset:12288
    ds_read_b64_tr_b16 v[78:79], v36 offset:13568
    ds_read_b128 v[52:55], v32 offset:0
    ds_read_b64_tr_b16 v[80:81], v37 offset:12288
    ds_read_b64_tr_b16 v[82:83], v37 offset:13568
    ds_read_b128 v[56:59], v32 offset:2048
    ds_read_b64_tr_b16 v[84:85], v38 offset:12288
    ds_read_b64_tr_b16 v[86:87], v38 offset:13568
    ds_read_b128 v[60:63], v32 offset:4096
    ds_read_b64_tr_b16 v[88:89], v39 offset:12288
    ds_read_b64_tr_b16 v[90:91], v39 offset:13568
    ds_read_b64_tr_b16 v[92:93], v40 offset:12288
    ds_read_b64_tr_b16 v[94:95], v40 offset:13568
P1_CL_KV:
    s_waitcnt lgkmcnt(0)
    v_mfma_f32_16x16x32_bf16 v[116:119], v[76:79], v[52:55], v[116:119]
    ds_read_b64_tr_b16 v[96:97], v36 offset:22528
    ds_read_b64_tr_b16 v[98:99], v36 offset:23808
    v_mfma_f32_16x16x32_bf16 v[136:139], v[76:79], v[56:59], v[136:139]
    ds_read_b128 v[64:67], v33 offset:0
    ds_read_b64_tr_b16 v[100:101], v37 offset:22528
    v_mfma_f32_16x16x32_bf16 v[156:159], v[76:79], v[60:63], v[156:159]
    ds_read_b64_tr_b16 v[102:103], v37 offset:23808
    ds_read_b128 v[68:71], v33 offset:2048
    v_mfma_f32_16x16x32_bf16 v[120:123], v[80:83], v[52:55], v[120:123]
    ds_read_b64_tr_b16 v[104:105], v38 offset:22528
    ds_read_b64_tr_b16 v[106:107], v38 offset:23808
    v_mfma_f32_16x16x32_bf16 v[140:143], v[80:83], v[56:59], v[140:143]
    ds_read_b128 v[72:75], v33 offset:4096
    ds_read_b64_tr_b16 v[108:109], v39 offset:22528
    v_mfma_f32_16x16x32_bf16 v[160:163], v[80:83], v[60:63], v[160:163]
    ds_read_b64_tr_b16 v[110:111], v39 offset:23808
    ds_read_b64_tr_b16 v[112:113], v40 offset:22528
    v_mfma_f32_16x16x32_bf16 v[124:127], v[84:87], v[52:55], v[124:127]
    ds_read_b64_tr_b16 v[114:115], v40 offset:23808
    v_mfma_f32_16x16x32_bf16 v[144:147], v[84:87], v[56:59], v[144:147]
    v_mfma_f32_16x16x32_bf16 v[164:167], v[84:87], v[60:63], v[164:167]
    v_mfma_f32_16x16x32_bf16 v[128:131], v[88:91], v[52:55], v[128:131]
    v_mfma_f32_16x16x32_bf16 v[148:151], v[88:91], v[56:59], v[148:151]
    v_mfma_f32_16x16x32_bf16 v[168:171], v[88:91], v[60:63], v[168:171]
    v_mfma_f32_16x16x32_bf16 v[132:135], v[92:95], v[52:55], v[132:135]
    v_mfma_f32_16x16x32_bf16 v[152:155], v[92:95], v[56:59], v[152:155]
    v_mfma_f32_16x16x32_bf16 v[172:175], v[92:95], v[60:63], v[172:175]
    s_waitcnt lgkmcnt(0)
    s_barrier
    v_mfma_f32_16x16x32_bf16 v[116:119], v[96:99], v[64:67], v[116:119]
    ds_read_b64_tr_b16 v[76:77], v36 offset:45056
    ds_read_b64_tr_b16 v[78:79], v36 offset:46336
    v_mfma_f32_16x16x32_bf16 v[136:139], v[96:99], v[68:71], v[136:139]
    ds_read_b128 v[52:55], v32 offset:32768
    ds_read_b64_tr_b16 v[80:81], v37 offset:45056
    v_mfma_f32_16x16x32_bf16 v[156:159], v[96:99], v[72:75], v[156:159]
    ds_read_b64_tr_b16 v[82:83], v37 offset:46336
    ds_read_b128 v[56:59], v32 offset:34816
    v_mfma_f32_16x16x32_bf16 v[120:123], v[100:103], v[64:67], v[120:123]
    ds_read_b64_tr_b16 v[84:85], v38 offset:45056
    ds_read_b64_tr_b16 v[86:87], v38 offset:46336
    v_mfma_f32_16x16x32_bf16 v[140:143], v[100:103], v[68:71], v[140:143]
    ds_read_b128 v[60:63], v32 offset:36864
    ds_read_b64_tr_b16 v[88:89], v39 offset:45056
    v_mfma_f32_16x16x32_bf16 v[160:163], v[100:103], v[72:75], v[160:163]
    ds_read_b64_tr_b16 v[90:91], v39 offset:46336
    ds_read_b64_tr_b16 v[92:93], v40 offset:45056
    v_mfma_f32_16x16x32_bf16 v[124:127], v[104:107], v[64:67], v[124:127]
    ds_read_b64_tr_b16 v[94:95], v40 offset:46336
    v_mfma_f32_16x16x32_bf16 v[144:147], v[104:107], v[68:71], v[144:147]
    v_mfma_f32_16x16x32_bf16 v[164:167], v[104:107], v[72:75], v[164:167]
    v_mfma_f32_16x16x32_bf16 v[128:131], v[108:111], v[64:67], v[128:131]
    v_mfma_f32_16x16x32_bf16 v[148:151], v[108:111], v[68:71], v[148:151]
    v_mfma_f32_16x16x32_bf16 v[168:171], v[108:111], v[72:75], v[168:171]
    v_mfma_f32_16x16x32_bf16 v[132:135], v[112:115], v[64:67], v[132:135]
    v_mfma_f32_16x16x32_bf16 v[152:155], v[112:115], v[68:71], v[152:155]
    v_mfma_f32_16x16x32_bf16 v[172:175], v[112:115], v[72:75], v[172:175]
    s_waitcnt lgkmcnt(0)
    v_mfma_f32_16x16x32_bf16 v[116:119], v[76:79], v[52:55], v[116:119]
    ds_read_b64_tr_b16 v[96:97], v36 offset:55296
    ds_read_b64_tr_b16 v[98:99], v36 offset:56576
    v_mfma_f32_16x16x32_bf16 v[136:139], v[76:79], v[56:59], v[136:139]
    ds_read_b128 v[64:67], v33 offset:32768
    ds_read_b64_tr_b16 v[100:101], v37 offset:55296
    v_mfma_f32_16x16x32_bf16 v[156:159], v[76:79], v[60:63], v[156:159]
    ds_read_b64_tr_b16 v[102:103], v37 offset:56576
    ds_read_b128 v[68:71], v33 offset:34816
    v_mfma_f32_16x16x32_bf16 v[120:123], v[80:83], v[52:55], v[120:123]
    ds_read_b64_tr_b16 v[104:105], v38 offset:55296
    ds_read_b64_tr_b16 v[106:107], v38 offset:56576
    v_mfma_f32_16x16x32_bf16 v[140:143], v[80:83], v[56:59], v[140:143]
    ds_read_b128 v[72:75], v33 offset:36864
    ds_read_b64_tr_b16 v[108:109], v39 offset:55296
    v_mfma_f32_16x16x32_bf16 v[160:163], v[80:83], v[60:63], v[160:163]
    ds_read_b64_tr_b16 v[110:111], v39 offset:56576
    ds_read_b64_tr_b16 v[112:113], v40 offset:55296
    v_mfma_f32_16x16x32_bf16 v[124:127], v[84:87], v[52:55], v[124:127]
    ds_read_b64_tr_b16 v[114:115], v40 offset:56576
    v_mfma_f32_16x16x32_bf16 v[144:147], v[84:87], v[56:59], v[144:147]
    v_mfma_f32_16x16x32_bf16 v[164:167], v[84:87], v[60:63], v[164:167]
    v_mfma_f32_16x16x32_bf16 v[128:131], v[88:91], v[52:55], v[128:131]
    v_mfma_f32_16x16x32_bf16 v[148:151], v[88:91], v[56:59], v[148:151]
    v_mfma_f32_16x16x32_bf16 v[168:171], v[88:91], v[60:63], v[168:171]
    v_mfma_f32_16x16x32_bf16 v[132:135], v[92:95], v[52:55], v[132:135]
    v_mfma_f32_16x16x32_bf16 v[152:155], v[92:95], v[56:59], v[152:155]
    v_mfma_f32_16x16x32_bf16 v[172:175], v[92:95], v[60:63], v[172:175]
    s_waitcnt lgkmcnt(0)
    s_barrier
    v_xor_b32 v32, 0x10000, v32
    v_xor_b32 v33, 0x10000, v33
    v_xor_b32 v36, 0x10000, v36
    v_xor_b32 v37, 0x10000, v37
    v_xor_b32 v38, 0x10000, v38
    v_xor_b32 v39, 0x10000, v39
    v_xor_b32 v40, 0x10000, v40
    v_mfma_f32_16x16x32_bf16 v[116:119], v[96:99], v[64:67], v[116:119]
    ds_read_b64_tr_b16 v[76:77], v36 offset:12288
    ds_read_b64_tr_b16 v[78:79], v36 offset:13568
    v_mfma_f32_16x16x32_bf16 v[136:139], v[96:99], v[68:71], v[136:139]
    ds_read_b128 v[52:55], v32 offset:0
    ds_read_b64_tr_b16 v[80:81], v37 offset:12288
    v_mfma_f32_16x16x32_bf16 v[156:159], v[96:99], v[72:75], v[156:159]
    ds_read_b64_tr_b16 v[82:83], v37 offset:13568
    ds_read_b128 v[56:59], v32 offset:2048
    v_mfma_f32_16x16x32_bf16 v[120:123], v[100:103], v[64:67], v[120:123]
    ds_read_b64_tr_b16 v[84:85], v38 offset:12288
    ds_read_b64_tr_b16 v[86:87], v38 offset:13568
    v_mfma_f32_16x16x32_bf16 v[140:143], v[100:103], v[68:71], v[140:143]
    ds_read_b128 v[60:63], v32 offset:4096
    ds_read_b64_tr_b16 v[88:89], v39 offset:12288
    v_mfma_f32_16x16x32_bf16 v[160:163], v[100:103], v[72:75], v[160:163]
    ds_read_b64_tr_b16 v[90:91], v39 offset:13568
    ds_read_b64_tr_b16 v[92:93], v40 offset:12288
    v_mfma_f32_16x16x32_bf16 v[124:127], v[104:107], v[64:67], v[124:127]
    ds_read_b64_tr_b16 v[94:95], v40 offset:13568
    v_mfma_f32_16x16x32_bf16 v[144:147], v[104:107], v[68:71], v[144:147]
    v_mfma_f32_16x16x32_bf16 v[164:167], v[104:107], v[72:75], v[164:167]
    v_mfma_f32_16x16x32_bf16 v[128:131], v[108:111], v[64:67], v[128:131]
    v_mfma_f32_16x16x32_bf16 v[148:151], v[108:111], v[68:71], v[148:151]
    v_mfma_f32_16x16x32_bf16 v[168:171], v[108:111], v[72:75], v[168:171]
    v_mfma_f32_16x16x32_bf16 v[132:135], v[112:115], v[64:67], v[132:135]
    v_mfma_f32_16x16x32_bf16 v[152:155], v[112:115], v[68:71], v[152:155]
    v_mfma_f32_16x16x32_bf16 v[172:175], v[112:115], v[72:75], v[172:175]
    s_add_u32 s59, s59, 1
    s_cmp_lt_u32 s59, 5
    s_cbranch_scc1 P1_CL_KV
    s_waitcnt lgkmcnt(0)
    s_setprio 0
    s_cmp_lg_u32 s38, 1
    s_cbranch_scc1 P1_NOWSW
    v_lshlrev_b32 v26, 4, v5
    s_mul_i32 s44, s39, 320
    s_add_u32 s44, s44, 66560
    v_add_u32 v26, s44, v26
    v_cmp_eq_u32 vcc, 15, v4
    s_nop 3
    s_and_saveexec_b64 s[70:71], vcc
    ds_write_b128 v26, v[156:159] offset:0
    ds_write_b128 v26, v[160:163] offset:64
    ds_write_b128 v26, v[164:167] offset:128
    ds_write_b128 v26, v[168:171] offset:192
    ds_write_b128 v26, v[172:175] offset:256
    s_mov_b64 exec, s[70:71]
P1_NOWSW:
    s_waitcnt lgkmcnt(0)
    s_barrier
    v_lshlrev_b32 v26, 3, v4
    s_mul_i32 s44, s38, 384
    s_add_u32 s44, s44, 65536
    v_add_u32 v26, s44, v26
    ds_read_b64 v[204:205], v26 offset:0
    ds_read_b64 v[206:207], v26 offset:128
    ds_read_b64 v[208:209], v26 offset:256
    v_lshlrev_b32 v26, 4, v5
    s_mul_i32 s44, s39, 320
    s_add_u32 s44, s44, 66560
    v_add_u32 v26, s44, v26
    ds_read_b128 v[176:179], v26 offset:0
    ds_read_b128 v[180:183], v26 offset:64
    ds_read_b128 v[184:187], v26 offset:128
    ds_read_b128 v[188:191], v26 offset:192
    ds_read_b128 v[192:195], v26 offset:256
    v_cmp_gt_u32 s[70:71], 2, v5
    v_mov_b32 v248, 0
    v_mov_b32 v249, s66
    v_cndmask_b32 v248, v248, v249, s[70:71]
    v_mov_b32 v249, v248
    v_mul_u32_u24 v26, 352, v4
    s_mul_i32 s44, s38, 16896
    v_add_u32 v26, s44, v26
    v_add_u32 v46, v46, v26
    v_add_u32 v47, v47, v26
    v_add_u32 v48, v48, v26
    v_add_u32 v49, v49, v26
    v_add_u32 v50, v50, v26
    ds_write_b64 v26, v[12:13] offset:320
    ds_write_b64 v26, v[12:13] offset:5952
    ds_write_b64 v26, v[12:13] offset:11584
    s_waitcnt lgkmcnt(3)
    v_pk_fma_f32 v[212:213], v[176:177], v[204:205], s[66:67] op_sel:[0,1,0] op_sel_hi:[1,1,1] neg_lo:[1,0,0] neg_hi:[1,0,0]
    v_pk_fma_f32 v[214:215], v[178:179], v[204:205], s[66:67] op_sel:[0,1,0] op_sel_hi:[1,1,1] neg_lo:[1,0,0] neg_hi:[1,0,0]
    v_pk_fma_f32 v[216:217], v[176:177], v[206:207], s[66:67] op_sel:[0,1,0] op_sel_hi:[1,1,1] neg_lo:[1,0,0] neg_hi:[1,0,0]
    v_pk_fma_f32 v[218:219], v[178:179], v[206:207], s[66:67] op_sel:[0,1,0] op_sel_hi:[1,1,1] neg_lo:[1,0,0] neg_hi:[1,0,0]
    v_pk_fma_f32 v[220:221], v[176:177], v[208:209], s[66:67] op_sel:[0,1,0] op_sel_hi:[1,1,1] neg_lo:[1,0,0] neg_hi:[1,0,0]
    v_pk_fma_f32 v[222:223], v[178:179], v[208:209], s[66:67] op_sel:[0,1,0] op_sel_hi:[1,1,1] neg_lo:[1,0,0] neg_hi:[1,0,0]
    v_pk_fma_f32 v[116:117], v[116:117], v[204:205], v[212:213] op_sel:[0,0,0] op_sel_hi:[1,0,1]
    v_pk_fma_f32 v[118:119], v[118:119], v[204:205], v[214:215] op_sel:[0,0,0] op_sel_hi:[1,0,1]
    v_pk_fma_f32 v[136:137], v[136:137], v[206:207], v[216:217] op_sel:[0,0,0] op_sel_hi:[1,0,1]
    v_pk_fma_f32 v[138:139], v[138:139], v[206:207], v[218:219] op_sel:[0,0,0] op_sel_hi:[1,0,1]
    v_pk_fma_f32 v[156:157], v[156:157], v[208:209], v[220:221] op_sel:[0,0,0] op_sel_hi:[1,0,1]
    v_pk_fma_f32 v[158:159], v[158:159], v[208:209], v[222:223] op_sel:[0,0,0] op_sel_hi:[1,0,1]
    v_pk_fma_f32 v[212:213], v[116:117], s[68:69], v[250:251]
    v_pk_fma_f32 v[214:215], v[118:119], s[68:69], v[250:251]
    v_pk_fma_f32 v[216:217], v[136:137], s[68:69], v[250:251]
    v_pk_fma_f32 v[218:219], v[138:139], s[68:69], v[250:251]
    v_pk_fma_f32 v[220:221], v[156:157], s[68:69], v[250:251]
    v_pk_fma_f32 v[222:223], v[158:159], s[68:69], v[250:251]
    v_exp_f32 v212, v212 clamp
    v_exp_f32 v213, v213 clamp
    v_exp_f32 v214, v214 clamp
    v_exp_f32 v215, v215 clamp
    v_exp_f32 v216, v216 clamp
    v_exp_f32 v217, v217 clamp
    v_exp_f32 v218, v218 clamp
    v_exp_f32 v219, v219 clamp
    v_exp_f32 v220, v220 clamp
    v_exp_f32 v221, v221 clamp
    v_exp_f32 v222, v222 clamp
    v_exp_f32 v223, v223 clamp
    v_max_f32 v116, s66, v116
    v_max_f32 v117, s66, v117
    v_max_f32 v118, s66, v118
    v_max_f32 v119, s66, v119
    v_max_f32 v136, s66, v136
    v_max_f32 v137, s66, v137
    v_max_f32 v138, s66, v138
    v_max_f32 v139, s66, v139
    v_max_f32 v156, s66, v156
    v_max_f32 v157, s66, v157
    v_max_f32 v158, s66, v158
    v_max_f32 v159, s66, v159
    v_pk_add_f32 v[116:117], v[116:117], v[212:213]
    v_pk_add_f32 v[118:119], v[118:119], v[214:215]
    v_pk_add_f32 v[136:137], v[136:137], v[216:217]
    v_pk_add_f32 v[138:139], v[138:139], v[218:219]
    v_pk_add_f32 v[156:157], v[156:157], v[220:221]
    v_pk_add_f32 v[158:159], v[158:159], v[222:223]
    v_cvt_pk_bf16_f32 v116, v116, v117
    v_cvt_pk_bf16_f32 v117, v118, v119
    v_and_b32 v116, v116, v200
    v_and_b32 v117, v117, v200
    ds_write_b64 v46, v[116:117] offset:0
    v_cvt_pk_bf16_f32 v136, v136, v137
    v_cvt_pk_bf16_f32 v137, v138, v139
    v_and_b32 v136, v136, v201
    v_and_b32 v137, v137, v201
    ds_write_b64 v46, v[136:137] offset:5632
    v_cvt_pk_bf16_f32 v156, v156, v157
    v_cvt_pk_bf16_f32 v157, v158, v159
    v_and_b32 v156, v156, v202
    v_and_b32 v157, v157, v202
    ds_write_b64 v46, v[156:157] offset:11264
    v_pk_fma_f32 v[212:213], v[180:181], v[204:205], s[66:67] op_sel:[0,1,0] op_sel_hi:[1,1,1] neg_lo:[1,0,0] neg_hi:[1,0,0]
    v_pk_fma_f32 v[214:215], v[182:183], v[204:205], s[66:67] op_sel:[0,1,0] op_sel_hi:[1,1,1] neg_lo:[1,0,0] neg_hi:[1,0,0]
    v_pk_fma_f32 v[216:217], v[180:181], v[206:207], s[66:67] op_sel:[0,1,0] op_sel_hi:[1,1,1] neg_lo:[1,0,0] neg_hi:[1,0,0]
    v_pk_fma_f32 v[218:219], v[182:183], v[206:207], s[66:67] op_sel:[0,1,0] op_sel_hi:[1,1,1] neg_lo:[1,0,0] neg_hi:[1,0,0]
    v_pk_fma_f32 v[220:221], v[180:181], v[208:209], s[66:67] op_sel:[0,1,0] op_sel_hi:[1,1,1] neg_lo:[1,0,0] neg_hi:[1,0,0]
    v_pk_fma_f32 v[222:223], v[182:183], v[208:209], s[66:67] op_sel:[0,1,0] op_sel_hi:[1,1,1] neg_lo:[1,0,0] neg_hi:[1,0,0]
    v_pk_fma_f32 v[120:121], v[120:121], v[204:205], v[212:213] op_sel:[0,0,0] op_sel_hi:[1,0,1]
    v_pk_fma_f32 v[122:123], v[122:123], v[204:205], v[214:215] op_sel:[0,0,0] op_sel_hi:[1,0,1]
    v_pk_fma_f32 v[140:141], v[140:141], v[206:207], v[216:217] op_sel:[0,0,0] op_sel_hi:[1,0,1]
    v_pk_fma_f32 v[142:143], v[142:143], v[206:207], v[218:219] op_sel:[0,0,0] op_sel_hi:[1,0,1]
    v_pk_fma_f32 v[160:161], v[160:161], v[208:209], v[220:221] op_sel:[0,0,0] op_sel_hi:[1,0,1]
    v_pk_fma_f32 v[162:163], v[162:163], v[208:209], v[222:223] op_sel:[0,0,0] op_sel_hi:[1,0,1]
    v_pk_fma_f32 v[212:213], v[120:121], s[68:69], v[250:251]
    v_pk_fma_f32 v[214:215], v[122:123], s[68:69], v[250:251]
    v_pk_fma_f32 v[216:217], v[140:141], s[68:69], v[250:251]
    v_pk_fma_f32 v[218:219], v[142:143], s[68:69], v[250:251]
    v_pk_fma_f32 v[220:221], v[160:161], s[68:69], v[250:251]
    v_pk_fma_f32 v[222:223], v[162:163], s[68:69], v[250:251]
    v_exp_f32 v212, v212 clamp
    v_exp_f32 v213, v213 clamp
    v_exp_f32 v214, v214 clamp
    v_exp_f32 v215, v215 clamp
    v_exp_f32 v216, v216 clamp
    v_exp_f32 v217, v217 clamp
    v_exp_f32 v218, v218 clamp
    v_exp_f32 v219, v219 clamp
    v_exp_f32 v220, v220 clamp
    v_exp_f32 v221, v221 clamp
    v_exp_f32 v222, v222 clamp
    v_exp_f32 v223, v223 clamp
    v_max_f32 v120, s66, v120
    v_max_f32 v121, s66, v121
    v_max_f32 v122, s66, v122
    v_max_f32 v123, s66, v123
    v_max_f32 v140, s66, v140
    v_max_f32 v141, s66, v141
    v_max_f32 v142, s66, v142
    v_max_f32 v143, s66, v143
    v_max_f32 v160, s66, v160
    v_max_f32 v161, s66, v161
    v_max_f32 v162, s66, v162
    v_max_f32 v163, s66, v163
    v_pk_add_f32 v[120:121], v[120:121], v[212:213]
    v_pk_add_f32 v[122:123], v[122:123], v[214:215]
    v_pk_add_f32 v[140:141], v[140:141], v[216:217]
    v_pk_add_f32 v[142:143], v[142:143], v[218:219]
    v_pk_add_f32 v[160:161], v[160:161], v[220:221]
    v_pk_add_f32 v[162:163], v[162:163], v[222:223]
    v_cvt_pk_bf16_f32 v120, v120, v121
    v_cvt_pk_bf16_f32 v121, v122, v123
    v_and_b32 v120, v120, v200
    v_and_b32 v121, v121, v200
    ds_write_b64 v47, v[120:121] offset:0
    v_cvt_pk_bf16_f32 v140, v140, v141
    v_cvt_pk_bf16_f32 v141, v142, v143
    v_and_b32 v140, v140, v201
    v_and_b32 v141, v141, v201
    ds_write_b64 v47, v[140:141] offset:5632
    v_cvt_pk_bf16_f32 v160, v160, v161
    v_cvt_pk_bf16_f32 v161, v162, v163
    v_and_b32 v160, v160, v202
    v_and_b32 v161, v161, v202
    ds_write_b64 v47, v[160:161] offset:11264
    v_pk_fma_f32 v[212:213], v[184:185], v[204:205], v[248:249] op_sel:[0,1,0] op_sel_hi:[1,1,1] neg_lo:[1,0,0] neg_hi:[1,0,0]
    v_pk_fma_f32 v[214:215], v[186:187], v[204:205], v[248:249] op_sel:[0,1,0] op_sel_hi:[1,1,1] neg_lo:[1,0,0] neg_hi:[1,0,0]
    v_pk_fma_f32 v[216:217], v[184:185], v[206:207], v[248:249] op_sel:[0,1,0] op_sel_hi:[1,1,1] neg_lo:[1,0,0] neg_hi:[1,0,0]
    v_pk_fma_f32 v[218:219], v[186:187], v[206:207], v[248:249] op_sel:[0,1,0] op_sel_hi:[1,1,1] neg_lo:[1,0,0] neg_hi:[1,0,0]
    v_pk_fma_f32 v[220:221], v[184:185], v[208:209], v[248:249] op_sel:[0,1,0] op_sel_hi:[1,1,1] neg_lo:[1,0,0] neg_hi:[1,0,0]
    v_pk_fma_f32 v[222:223], v[186:187], v[208:209], v[248:249] op_sel:[0,1,0] op_sel_hi:[1,1,1] neg_lo:[1,0,0] neg_hi:[1,0,0]
    v_pk_fma_f32 v[124:125], v[124:125], v[204:205], v[212:213] op_sel:[0,0,0] op_sel_hi:[1,0,1]
    v_pk_fma_f32 v[126:127], v[126:127], v[204:205], v[214:215] op_sel:[0,0,0] op_sel_hi:[1,0,1]
    v_pk_fma_f32 v[144:145], v[144:145], v[206:207], v[216:217] op_sel:[0,0,0] op_sel_hi:[1,0,1]
    v_pk_fma_f32 v[146:147], v[146:147], v[206:207], v[218:219] op_sel:[0,0,0] op_sel_hi:[1,0,1]
    v_pk_fma_f32 v[164:165], v[164:165], v[208:209], v[220:221] op_sel:[0,0,0] op_sel_hi:[1,0,1]
    v_pk_fma_f32 v[166:167], v[166:167], v[208:209], v[222:223] op_sel:[0,0,0] op_sel_hi:[1,0,1]
    v_pk_fma_f32 v[212:213], v[124:125], s[68:69], v[250:251]
    v_pk_fma_f32 v[214:215], v[126:127], s[68:69], v[250:251]
    v_pk_fma_f32 v[216:217], v[144:145], s[68:69], v[250:251]
    v_pk_fma_f32 v[218:219], v[146:147], s[68:69], v[250:251]
    v_pk_fma_f32 v[220:221], v[164:165], s[68:69], v[250:251]
    v_pk_fma_f32 v[222:223], v[166:167], s[68:69], v[250:251]
    v_exp_f32 v212, v212 clamp
    v_exp_f32 v213, v213 clamp
    v_exp_f32 v214, v214 clamp
    v_exp_f32 v215, v215 clamp
    v_exp_f32 v216, v216 clamp
    v_exp_f32 v217, v217 clamp
    v_exp_f32 v218, v218 clamp
    v_exp_f32 v219, v219 clamp
    v_exp_f32 v220, v220 clamp
    v_exp_f32 v221, v221 clamp
    v_exp_f32 v222, v222 clamp
    v_exp_f32 v223, v223 clamp
    v_max_f32 v224, s66, v124
    v_add_f32 v224, v224, v212
    v_cndmask_b32 v124, v124, v224, s[70:71]
    v_max_f32 v225, s66, v125
    v_add_f32 v225, v225, v213
    v_cndmask_b32 v125, v125, v225, s[70:71]
    v_max_f32 v226, s66, v126
    v_add_f32 v226, v226, v214
    v_cndmask_b32 v126, v126, v226, s[70:71]
    v_max_f32 v227, s66, v127
    v_add_f32 v227, v227, v215
    v_cndmask_b32 v127, v127, v227, s[70:71]
    v_max_f32 v224, s66, v144
    v_add_f32 v224, v224, v216
    v_cndmask_b32 v144, v144, v224, s[70:71]
    v_max_f32 v225, s66, v145
    v_add_f32 v225, v225, v217
    v_cndmask_b32 v145, v145, v225, s[70:71]
    v_max_f32 v226, s66, v146
    v_add_f32 v226, v226, v218
    v_cndmask_b32 v146, v146, v226, s[70:71]
    v_max_f32 v227, s66, v147
    v_add_f32 v227, v227, v219
    v_cndmask_b32 v147, v147, v227, s[70:71]
    v_max_f32 v224, s66, v164
    v_add_f32 v224, v224, v220
    v_cndmask_b32 v164, v164, v224, s[70:71]
    v_max_f32 v225, s66, v165
    v_add_f32 v225, v225, v221
    v_cndmask_b32 v165, v165, v225, s[70:71]
    v_max_f32 v226, s66, v166
    v_add_f32 v226, v226, v222
    v_cndmask_b32 v166, v166, v226, s[70:71]
    v_max_f32 v227, s66, v167
    v_add_f32 v227, v227, v223
    v_cndmask_b32 v167, v167, v227, s[70:71]
    v_cvt_pk_bf16_f32 v124, v124, v125
    v_cvt_pk_bf16_f32 v125, v126, v127
    v_and_b32 v124, v124, v200
    v_and_b32 v125, v125, v200
    ds_write_b64 v48, v[124:125] offset:0
    v_cvt_pk_bf16_f32 v144, v144, v145
    v_cvt_pk_bf16_f32 v145, v146, v147
    v_and_b32 v144, v144, v201
    v_and_b32 v145, v145, v201
    ds_write_b64 v48, v[144:145] offset:5632
    v_cvt_pk_bf16_f32 v164, v164, v165
    v_cvt_pk_bf16_f32 v165, v166, v167
    v_and_b32 v164, v164, v202
    v_and_b32 v165, v165, v202
    ds_write_b64 v48, v[164:165] offset:11264
    v_pk_fma_f32 v[212:213], v[188:189], v[204:205], 0 op_sel:[0,1,0] op_sel_hi:[1,1,1] neg_lo:[1,0,0] neg_hi:[1,0,0]
    v_pk_fma_f32 v[214:215], v[190:191], v[204:205], 0 op_sel:[0,1,0] op_sel_hi:[1,1,1] neg_lo:[1,0,0] neg_hi:[1,0,0]
    v_pk_fma_f32 v[216:217], v[188:189], v[206:207], 0 op_sel:[0,1,0] op_sel_hi:[1,1,1] neg_lo:[1,0,0] neg_hi:[1,0,0]
    v_pk_fma_f32 v[218:219], v[190:191], v[206:207], 0 op_sel:[0,1,0] op_sel_hi:[1,1,1] neg_lo:[1,0,0] neg_hi:[1,0,0]
    v_pk_fma_f32 v[220:221], v[188:189], v[208:209], 0 op_sel:[0,1,0] op_sel_hi:[1,1,1] neg_lo:[1,0,0] neg_hi:[1,0,0]
    v_pk_fma_f32 v[222:223], v[190:191], v[208:209], 0 op_sel:[0,1,0] op_sel_hi:[1,1,1] neg_lo:[1,0,0] neg_hi:[1,0,0]
    v_pk_fma_f32 v[128:129], v[128:129], v[204:205], v[212:213] op_sel:[0,0,0] op_sel_hi:[1,0,1]
    v_pk_fma_f32 v[130:131], v[130:131], v[204:205], v[214:215] op_sel:[0,0,0] op_sel_hi:[1,0,1]
    v_pk_fma_f32 v[148:149], v[148:149], v[206:207], v[216:217] op_sel:[0,0,0] op_sel_hi:[1,0,1]
    v_pk_fma_f32 v[150:151], v[150:151], v[206:207], v[218:219] op_sel:[0,0,0] op_sel_hi:[1,0,1]
    v_pk_fma_f32 v[168:169], v[168:169], v[208:209], v[220:221] op_sel:[0,0,0] op_sel_hi:[1,0,1]
    v_pk_fma_f32 v[170:171], v[170:171], v[208:209], v[222:223] op_sel:[0,0,0] op_sel_hi:[1,0,1]
    v_cvt_pk_bf16_f32 v128, v128, v129
    v_cvt_pk_bf16_f32 v129, v130, v131
    v_and_b32 v128, v128, v200
    v_and_b32 v129, v129, v200
    ds_write_b64 v49, v[128:129] offset:0
    v_cvt_pk_bf16_f32 v148, v148, v149
    v_cvt_pk_bf16_f32 v149, v150, v151
    v_and_b32 v148, v148, v201
    v_and_b32 v149, v149, v201
    ds_write_b64 v49, v[148:149] offset:5632
    v_cvt_pk_bf16_f32 v168, v168, v169
    v_cvt_pk_bf16_f32 v169, v170, v171
    v_and_b32 v168, v168, v202
    v_and_b32 v169, v169, v202
    ds_write_b64 v49, v[168:169] offset:11264
    v_pk_fma_f32 v[212:213], v[192:193], v[204:205], 0 op_sel:[0,1,0] op_sel_hi:[1,1,1] neg_lo:[1,0,0] neg_hi:[1,0,0]
    v_pk_fma_f32 v[214:215], v[194:195], v[204:205], 0 op_sel:[0,1,0] op_sel_hi:[1,1,1] neg_lo:[1,0,0] neg_hi:[1,0,0]
    v_pk_fma_f32 v[216:217], v[192:193], v[206:207], 0 op_sel:[0,1,0] op_sel_hi:[1,1,1] neg_lo:[1,0,0] neg_hi:[1,0,0]
    v_pk_fma_f32 v[218:219], v[194:195], v[206:207], 0 op_sel:[0,1,0] op_sel_hi:[1,1,1] neg_lo:[1,0,0] neg_hi:[1,0,0]
    v_pk_fma_f32 v[220:221], v[192:193], v[208:209], 0 op_sel:[0,1,0] op_sel_hi:[1,1,1] neg_lo:[1,0,0] neg_hi:[1,0,0]
    v_pk_fma_f32 v[222:223], v[194:195], v[208:209], 0 op_sel:[0,1,0] op_sel_hi:[1,1,1] neg_lo:[1,0,0] neg_hi:[1,0,0]
    v_pk_fma_f32 v[132:133], v[132:133], v[204:205], v[212:213] op_sel:[0,0,0] op_sel_hi:[1,0,1]
    v_pk_fma_f32 v[134:135], v[134:135], v[204:205], v[214:215] op_sel:[0,0,0] op_sel_hi:[1,0,1]
    v_pk_fma_f32 v[152:153], v[152:153], v[206:207], v[216:217] op_sel:[0,0,0] op_sel_hi:[1,0,1]
    v_pk_fma_f32 v[154:155], v[154:155], v[206:207], v[218:219] op_sel:[0,0,0] op_sel_hi:[1,0,1]
    v_pk_fma_f32 v[172:173], v[172:173], v[208:209], v[220:221] op_sel:[0,0,0] op_sel_hi:[1,0,1]
    v_pk_fma_f32 v[174:175], v[174:175], v[208:209], v[222:223] op_sel:[0,0,0] op_sel_hi:[1,0,1]
    v_cvt_pk_bf16_f32 v132, v132, v133
    v_cvt_pk_bf16_f32 v133, v134, v135
    v_and_b32 v132, v132, v200
    v_and_b32 v133, v133, v200
    ds_write_b64 v50, v[132:133] offset:0
    v_cvt_pk_bf16_f32 v152, v152, v153
    v_cvt_pk_bf16_f32 v153, v154, v155
    v_and_b32 v152, v152, v201
    v_and_b32 v153, v153, v201
    ds_write_b64 v50, v[152:153] offset:5632
    v_cvt_pk_bf16_f32 v172, v172, v173
    v_cvt_pk_bf16_f32 v173, v174, v175
    v_and_b32 v172, v172, v202
    v_and_b32 v173, v173, v202
    ds_write_b64 v50, v[172:173] offset:11264
    v_lshl_add_u32 v26, v5, 3, v6
    v_mul_u32_u24 v26, 352, v26
    s_mul_i32 s44, s37, 40
    v_lshlrev_b32 v27, 3, v7
    v_add_u32 v27, s44, v27
    v_add_u32 v28, v26, v27
    s_add_u32 s45, s44, 32
    v_add_u32 v29, s45, v26
    v_add_u32 v30, 160, v28
    s_add_u32 s45, s44, 192
    v_mov_b32 v31, s45
    v_mov_b32 v27, 320
    v_cmp_eq_u32 vcc, 0, v7
    s_nop 1
    v_cndmask_b32 v31, v27, v31, vcc
    v_add_u32 v31, v26, v31
    s_waitcnt lgkmcnt(0)
    s_barrier
    ds_read_b64_tr_b16 v[52:53], v28 offset:0
    ds_read_b64_tr_b16 v[54:55], v28 offset:1408
    ds_read_b64_tr_b16 v[56:57], v29 offset:0
    ds_read_b64_tr_b16 v[58:59], v29 offset:1408
    ds_read_b64_tr_b16 v[60:61], v30 offset:0
    ds_read_b64_tr_b16 v[62:63], v30 offset:1408
    ds_read_b64_tr_b16 v[64:65], v31 offset:0
    ds_read_b64_tr_b16 v[66:67], v31 offset:1408
    ds_read_b64_tr_b16 v[68:69], v28 offset:11264
    ds_read_b64_tr_b16 v[70:71], v28 offset:12672
    ds_read_b64_tr_b16 v[72:73], v29 offset:11264
    ds_read_b64_tr_b16 v[74:75], v29 offset:12672
    ds_read_b64_tr_b16 v[76:77], v30 offset:11264
    ds_read_b64_tr_b16 v[78:79], v30 offset:12672
    ds_read_b64_tr_b16 v[80:81], v31 offset:11264
    ds_read_b64_tr_b16 v[82:83], v31 offset:12672
    ds_read_b64_tr_b16 v[84:85], v28 offset:22528
    ds_read_b64_tr_b16 v[86:87], v28 offset:23936
    ds_read_b64_tr_b16 v[88:89], v29 offset:22528
    ds_read_b64_tr_b16 v[90:91], v29 offset:23936
    ds_read_b64_tr_b16 v[92:93], v30 offset:22528
    ds_read_b64_tr_b16 v[94:95], v30 offset:23936
    ds_read_b64_tr_b16 v[96:97], v31 offset:22528
    ds_read_b64_tr_b16 v[98:99], v31 offset:23936
    s_waitcnt lgkmcnt(8)
    v_mfma_f32_16x16x32_bf16 v[116:119], v[52:55], v[60:63], 0
    v_mfma_f32_16x16x32_bf16 v[120:123], v[52:55], v[64:67], 0
    v_mfma_f32_16x16x32_bf16 v[124:127], v[56:59], v[60:63], 0
    v_mfma_f32_16x16x32_bf16 v[128:131], v[56:59], v[64:67], 0
    v_mfma_f32_16x16x32_bf16 v[116:119], v[68:71], v[76:79], v[116:119]
    v_mfma_f32_16x16x32_bf16 v[120:123], v[68:71], v[80:83], v[120:123]
    v_mfma_f32_16x16x32_bf16 v[124:127], v[72:75], v[76:79], v[124:127]
    v_mfma_f32_16x16x32_bf16 v[128:131], v[72:75], v[80:83], v[128:131]
    s_waitcnt lgkmcnt(0)
    v_mfma_f32_16x16x32_bf16 v[116:119], v[84:87], v[92:95], v[116:119]
    v_mfma_f32_16x16x32_bf16 v[120:123], v[84:87], v[96:99], v[120:123]
    v_mfma_f32_16x16x32_bf16 v[124:127], v[88:91], v[92:95], v[124:127]
    v_mfma_f32_16x16x32_bf16 v[128:131], v[88:91], v[96:99], v[128:131]
    s_mul_i32 s44, s37, 1792
    s_add_u32 s44, s44, 40960
    v_mul_u32_u24 v26, 80, v4
    v_lshl_add_u32 v27, v5, 4, v26
    v_add_u32 v27, s44, v27
    v_mov_b32 v31, 48128
    v_add_u32 v28, 64, v26
    v_add_u32 v28, s44, v28
    v_cmp_eq_u32 s[70:71], 0, v5
    v_cmp_ge_u32 vcc, 4, v4
    v_add_u32 v29, 1280, v27
    v_add_u32 v30, 1280, v28
    v_cndmask_b32 v28, v31, v28, s[70:71]
    v_cndmask_b32 v29, v31, v29, vcc
    v_cndmask_b32 v30, v31, v30, vcc
    v_cndmask_b32 v30, v31, v30, s[70:71]
    ds_write_b128 v27, v[116:119]
    ds_write_b128 v29, v[120:123]
    ds_write_b128 v28, v[124:127]
    ds_write_b128 v30, v[128:131]
    v_lshlrev_b32 v26, 2, v3
    v_add_u32 v27, s44, v26
    s_waitcnt lgkmcnt(0)
    ds_read_b32 v52, v27 offset:0
    ds_read_b32 v53, v27 offset:256
    ds_read_b32 v54, v27 offset:512
    ds_read_b32 v55, v27 offset:768
    ds_read_b32 v56, v27 offset:1024
    ds_read_b32 v57, v27 offset:1280
    ds_read_b32 v58, v27 offset:1536
    s_lshl_b32 s44, s34, 2
    s_add_u32 s44, s44, s37
    s_mul_i32 s44, s44, 1680
    s_waitcnt lgkmcnt(0)
    buffer_atomic_add_f32 v52, v26, s[40:43], s44 offen offset:0
    buffer_atomic_add_f32 v53, v26, s[40:43], s44 offen offset:256
    buffer_atomic_add_f32 v54, v26, s[40:43], s44 offen offset:512
    buffer_atomic_add_f32 v55, v26, s[40:43], s44 offen offset:768
    buffer_atomic_add_f32 v56, v26, s[40:43], s44 offen offset:1024
    buffer_atomic_add_f32 v57, v26, s[40:43], s44 offen offset:1280
    v_cmp_gt_u32 vcc, 36, v3
    s_nop 3
    s_and_saveexec_b64 s[70:71], vcc
    buffer_atomic_add_f32 v58, v26, s[40:43], s44 offen offset:1536
    s_mov_b64 exec, s[70:71]
    s_endpgm
P1_Q:
    s_sub_u32 s33, s33, 22
    s_mul_i32 s47, s32, 10
    s_add_u32 s57, s47, s33
    s_and_b32 s35, s32, 3
    s_lshl_b32 s44, s35, 1
    s_add_u32 s44, s44, s33
    s_sub_u32 s44, s44, 8
    s_cmp_ge_u32 s33, 8
    s_cselect_b32 s34, s44, s33
    s_cselect_b32 s35, 4, s35
    s_lshr_b32 s44, s32, 2
    s_lshl_b32 s44, s44, 3
    s_add_u32 s34, s34, s44
    s_cmp_lt_u32 s36, 4
    s_cbranch_scc1 P1_QC
    v_lshrrev_b32 v26, 3, v3
    v_and_b32 v27, 7, v3
    v_xor_b32 v27, v27, v26
    v_and_b32 v27, 7, v27
    v_lshlrev_b32 v27, 4, v27
    v_mul_u32_u24 v16, 1280, v26
    v_add_u32 v16, v16, v27
    v_add_u32 v17, 9216, v16
    v_add_u32 v18, 18432, v16
    v_add_u32 v19, 27648, v16
    s_mul_i32 s60, s37, 4096
    v_add_u32 v32, s60, v1
    s_lshl_b32 s61, s34, 7
    s_lshl_b32 s62, s37, 5
    s_add_u32 s61, s61, s62
    s_mul_i32 s61, s61, 1280
    s_lshl_b32 s63, s37, 12
    s_add_u32 s63, s63, 16384
    s_mov_b32 s56, 0
    v_or_b32 v26, 0, v5
    v_lshlrev_b32 v26, 1, v26
    v_xor_b32 v26, v26, v4
    v_lshlrev_b32 v26, 4, v26
    v_mul_u32_u24 v27, 3840, v5
    v_add_u32 v26, v26, v27
    v_add_u32 v20, 0, v26
    v_or_b32 v26, 0, v5
    v_lshlrev_b32 v26, 1, v26
    v_xor_b32 v26, v26, v4
    v_lshlrev_b32 v26, 4, v26
    v_mul_u32_u24 v27, 3840, v5
    v_add_u32 v26, v26, v27
    v_add_u32 v21, 14336, v26
    v_or_b32 v26, 4, v5
    v_lshlrev_b32 v26, 1, v26
    v_xor_b32 v26, v26, v4
    v_lshlrev_b32 v26, 4, v26
    v_mul_u32_u24 v27, 3840, v5
    v_add_u32 v26, v26, v27
    v_add_u32 v22, 28672, v26
    v_or_b32 v26, 4, v5
    v_lshlrev_b32 v26, 1, v26
    v_xor_b32 v26, v26, v4
    v_lshlrev_b32 v26, 4, v26
    v_mul_u32_u24 v27, 3840, v5
    v_add_u32 v26, v26, v27
    v_add_u32 v23, 43008, v26
    s_lshl_b32 s62, s35, 8
    s_mul_i32 s44, s37, 61440
    s_add_u32 s62, s62, s44
    s_mul_i32 s38, s34, 0x199a
    s_lshr_b32 s38, s38, 16
    s_mul_i32 s38, s38, 10
    s_sub_u32 s38, s34, s38
    s_lshl_b32 s39, s38, 7
    s_add_u32 s61, s61, s39
    s_mul_i32 s39, s38, 245760
    s_add_u32 s62, s62, s39
    s_waitcnt lgkmcnt(0)
    s_mov_b32 s12, s4
    s_mov_b32 s13, s5
    s_mov_b32 s14, 0x280000
    s_mov_b32 s15, 0x20000
    s_mov_b32 s16, s6
    s_mov_b32 s17, s7
    s_mov_b32 s18, 0x258000
    s_mov_b32 s19, 0x20000
    s_mov_b32 s28, s8
    s_mov_b32 s29, s9
    s_mov_b32 s30, 0x100
    s_mov_b32 s31, 0x20000
    s_mov_b32 s40, s10
    s_mov_b32 s41, s11
    s_mov_b32 s42, 0x10000
    s_mov_b32 s43, 0x20000
    s_add_u32 m0, s60, s56
    s_nop 0
    buffer_load_dwordx4 v16, s[12:15], s61 offen offset:0 lds
    buffer_load_dwordx4 v17, s[12:15], s61 offen offset:1024 lds
    buffer_load_dwordx4 v18, s[12:15], s61 offen offset:2048 lds
    buffer_load_dwordx4 v19, s[12:15], s61 offen offset:3072 lds
    s_add_u32 m0, s63, s56
    s_nop 0
    buffer_load_dwordx4 v20, s[16:19], s62 offen offset:0 lds
    buffer_load_dwordx4 v21, s[16:19], s62 offen offset:1024 lds
    buffer_load_dwordx4 v22, s[16:19], s62 offen offset:2048 lds
    buffer_load_dwordx4 v23, s[16:19], s62 offen offset:3072 lds
    s_add_u32 s38, s38, 1
    s_cmp_eq_u32 s38, 10
    s_cselect_b32 s39, 1280, 0
    s_cselect_b32 s26, 2457600, 0
    s_cselect_b32 s38, 0, s38
    s_sub_u32 s61, s61, s39
    s_sub_u32 s62, s62, s26
    s_add_u32 s61, s61, 128
    s_add_u32 s62, s62, 245760
    s_add_u32 s56, s56, 32768
    s_and_b32 s56, s56, 0x1ffff
    s_add_u32 m0, s60, s56
    s_nop 0
    buffer_load_dwordx4 v16, s[12:15], s61 offen offset:0 lds
    buffer_load_dwordx4 v17, s[12:15], s61 offen offset:1024 lds
    buffer_load_dwordx4 v18, s[12:15], s61 offen offset:2048 lds
    buffer_load_dwordx4 v19, s[12:15], s61 offen offset:3072 lds
    s_add_u32 m0, s63, s56
    s_nop 0
    buffer_load_dwordx4 v20, s[16:19], s62 offen offset:0 lds
    buffer_load_dwordx4 v21, s[16:19], s62 offen offset:1024 lds
    buffer_load_dwordx4 v22, s[16:19], s62 offen offset:2048 lds
    buffer_load_dwordx4 v23, s[16:19], s62 offen offset:3072 lds
    s_add_u32 s38, s38, 1
    s_cmp_eq_u32 s38, 10
    s_cselect_b32 s39, 1280, 0
    s_cselect_b32 s26, 2457600, 0
    s_cselect_b32 s38, 0, s38
    s_sub_u32 s61, s61, s39
    s_sub_u32 s62, s62, s26
    s_add_u32 s61, s61, 128
    s_add_u32 s62, s62, 245760
    s_add_u32 s56, s56, 32768
    s_and_b32 s56, s56, 0x1ffff
    s_lshl_b32 s44, s34, 7
    v_and_b32 v248, 31, v3
    v_lshlrev_b32 v248, 2, v248
    v_and_b32 v26, 31, v3
    s_lshl_b32 s45, s37, 5
    v_add_u32 v26, s45, v26
    v_lshlrev_b32 v246, 3, v26
    s_lshl_b32 s87, s44, 3
    s_sub_u32 s45, 2048, s44
    s_min_u32 s45, s45, 128
    v_cmp_gt_u32 s[46:47], s45, v26
    s_add_u32 s48, s10, 0x34000
    s_addc_u32 s49, s11, 0
    s_mov_b32 s50, 0x4000
    s_mov_b32 s51, 0x20000
    s_waitcnt vmcnt(8)
    s_barrier
    s_add_u32 m0, s60, s56
    s_nop 0
    buffer_load_dwordx4 v16, s[12:15], s61 offen offset:0 lds
    buffer_load_dwordx4 v17, s[12:15], s61 offen offset:1024 lds
    buffer_load_dwordx4 v18, s[12:15], s61 offen offset:2048 lds
    buffer_load_dwordx4 v19, s[12:15], s61 offen offset:3072 lds
    s_add_u32 m0, s63, s56
    s_nop 0
    buffer_load_dwordx4 v20, s[16:19], s62 offen offset:0 lds
    buffer_load_dwordx4 v21, s[16:19], s62 offen offset:1024 lds
    buffer_load_dwordx4 v22, s[16:19], s62 offen offset:2048 lds
    buffer_load_dwordx4 v23, s[16:19], s62 offen offset:3072 lds
    s_add_u32 s38, s38, 1
    s_cmp_eq_u32 s38, 10
    s_cselect_b32 s39, 1280, 0
    s_cselect_b32 s26, 2457600, 0
    s_cselect_b32 s38, 0, s38
    s_sub_u32 s61, s61, s39
    s_sub_u32 s62, s62, s26
    s_add_u32 s61, s61, 128
    s_add_u32 s62, s62, 245760
    s_add_u32 s56, s56, 32768
    s_and_b32 s56, s56, 0x1ffff
    v_lshrrev_b32 v26, 5, v3
    v_mul_u32_u24 v26, 1280, v26
    v_and_b32 v27, 31, v3
    v_lshl_add_u32 v26, v27, 3, v26
    s_lshl_b32 s44, s2, 3
    s_lshl_b32 s45, s37, 1
    s_add_u32 s44, s44, s45
    s_mul_i32 s45, s44, 1280
    buffer_load_dwordx2 v[40:41], v26, s[12:15], s45 offen offset:0
    buffer_load_dwordx2 v[42:43], v26, s[12:15], s45 offen offset:256
    buffer_load_dwordx2 v[44:45], v26, s[12:15], s45 offen offset:512
    buffer_load_dwordx2 v[46:47], v26, s[12:15], s45 offen offset:768
    buffer_load_dwordx2 v[48:49], v26, s[12:15], s45 offen offset:1024
    s_add_u32 m0, s60, s56
    s_nop 0
    buffer_load_dwordx4 v16, s[12:15], s61 offen offset:0 lds
    buffer_load_dwordx4 v17, s[12:15], s61 offen offset:1024 lds
    buffer_load_dwordx4 v18, s[12:15], s61 offen offset:2048 lds
    buffer_load_dwordx4 v19, s[12:15], s61 offen offset:3072 lds
    s_add_u32 m0, s63, s56
    s_nop 0
    buffer_load_dwordx4 v20, s[16:19], s62 offen offset:0 lds
    buffer_load_dwordx4 v21, s[16:19], s62 offen offset:1024 lds
    buffer_load_dwordx4 v22, s[16:19], s62 offen offset:2048 lds
    buffer_load_dwordx4 v23, s[16:19], s62 offen offset:3072 lds
    s_add_u32 s38, s38, 1
    s_cmp_eq_u32 s38, 10
    s_cselect_b32 s39, 1280, 0
    s_cselect_b32 s26, 2457600, 0
    s_cselect_b32 s38, 0, s38
    s_sub_u32 s61, s61, s39
    s_sub_u32 s62, s62, s26
    s_add_u32 s61, s61, 128
    s_add_u32 s62, s62, 245760
    s_add_u32 s56, s56, 32768
    s_and_b32 s56, s56, 0x1ffff
    s_waitcnt vmcnt(21)
    s_barrier
    s_add_u32 m0, s60, s56
    s_nop 0
    buffer_load_dwordx4 v16, s[12:15], s61 offen offset:0 lds
    buffer_load_dwordx4 v17, s[12:15], s61 offen offset:1024 lds
    buffer_load_dwordx4 v18, s[12:15], s61 offen offset:2048 lds
    buffer_load_dwordx4 v19, s[12:15], s61 offen offset:3072 lds
    s_add_u32 m0, s63, s56
    s_nop 0
    buffer_load_dwordx4 v20, s[16:19], s62 offen offset:0 lds
    buffer_load_dwordx4 v21, s[16:19], s62 offen offset:1024 lds
    buffer_load_dwordx4 v22, s[16:19], s62 offen offset:2048 lds
    buffer_load_dwordx4 v23, s[16:19], s62 offen offset:3072 lds
    s_add_u32 s38, s38, 1
    s_cmp_eq_u32 s38, 10
    s_cselect_b32 s39, 1280, 0
    s_cselect_b32 s26, 2457600, 0
    s_cselect_b32 s38, 0, s38
    s_sub_u32 s61, s61, s39
    s_sub_u32 s62, s62, s26
    s_add_u32 s61, s61, 128
    s_add_u32 s62, s62, 245760
    s_add_u32 s56, s56, 32768
    s_and_b32 s56, s56, 0x1ffff
    s_waitcnt vmcnt(16)
    v_mov_b32 v60, 0
    v_mov_b32 v61, 0
    v_mov_b32 v62, 0
    v_mov_b32 v63, 0
    v_lshlrev_b32 v64, 16, v40
    v_and_b32 v65, 0xffff0000, v40
    v_add_f32 v60, v60, v64
    v_add_f32 v61, v61, v65
    v_fma_f32 v62, v64, v64, v62
    v_fma_f32 v63, v65, v65, v63
    v_lshlrev_b32 v66, 16, v41
    v_and_b32 v67, 0xffff0000, v41
    v_add_f32 v60, v60, v66
    v_add_f32 v61, v61, v67
    v_fma_f32 v62, v66, v66, v62
    v_fma_f32 v63, v67, v67, v63
    v_lshlrev_b32 v64, 16, v42
    v_and_b32 v65, 0xffff0000, v42
    v_add_f32 v60, v60, v64
    v_add_f32 v61, v61, v65
    v_fma_f32 v62, v64, v64, v62
    v_fma_f32 v63, v65, v65, v63
    v_lshlrev_b32 v66, 16, v43
    v_and_b32 v67, 0xffff0000, v43
    v_add_f32 v60, v60, v66
    v_add_f32 v61, v61, v67
    v_fma_f32 v62, v66, v66, v62
    v_fma_f32 v63, v67, v67, v63
    v_lshlrev_b32 v64, 16, v44
    v_and_b32 v65, 0xffff0000, v44
    v_add_f32 v60, v60, v64
    v_add_f32 v61, v61, v65
    v_fma_f32 v62, v64, v64, v62
    v_fma_f32 v63, v65, v65, v63
    v_lshlrev_b32 v66, 16, v45
    v_and_b32 v67, 0xffff0000, v45
    v_add_f32 v60, v60, v66
    v_add_f32 v61, v61, v67
    v_fma_f32 v62, v66, v66, v62
    v_fma_f32 v63, v67, v67, v63
    v_lshlrev_b32 v64, 16, v46
    v_and_b32 v65, 0xffff0000, v46
    v_add_f32 v60, v60, v64
    v_add_f32 v61, v61, v65
    v_fma_f32 v62, v64, v64, v62
    v_fma_f32 v63, v65, v65, v63
    v_lshlrev_b32 v66, 16, v47
    v_and_b32 v67, 0xffff0000, v47
    v_add_f32 v60, v60, v66
    v_add_f32 v61, v61, v67
    v_fma_f32 v62, v66, v66, v62
    v_fma_f32 v63, v67, v67, v63
    v_lshlrev_b32 v64, 16, v48
    v_and_b32 v65, 0xffff0000, v48
    v_add_f32 v60, v60, v64
    v_add_f32 v61, v61, v65
    v_fma_f32 v62, v64, v64, v62
    v_fma_f32 v63, v65, v65, v63
    v_lshlrev_b32 v66, 16, v49
    v_and_b32 v67, 0xffff0000, v49
    v_add_f32 v60, v60, v66
    v_add_f32 v61, v61, v67
    v_fma_f32 v62, v66, v66, v62
    v_fma_f32 v63, v67, v67, v63
    v_add_f32 v60, v60, v61
    v_add_f32 v62, v62, v63
    s_nop 0
    v_add_f32_dpp v60, v60, v60 quad_perm:[1,0,3,2] row_mask:0xf bank_mask:0xf
    s_nop 1
    v_add_f32_dpp v60, v60, v60 quad_perm:[2,3,0,1] row_mask:0xf bank_mask:0xf
    s_nop 1
    v_add_f32_dpp v60, v60, v60 row_half_mirror row_mask:0xf bank_mask:0xf
    s_nop 1
    v_add_f32_dpp v60, v60, v60 row_mirror row_mask:0xf bank_mask:0xf
    v_mov_b32 v64, v60
    s_nop 1
    v_permlane16_swap_b32 v60, v64
    v_add_f32 v60, v60, v64
    v_add_f32_dpp v62, v62, v62 quad_perm:[1,0,3,2] row_mask:0xf bank_mask:0xf
    s_nop 1
    v_add_f32_dpp v62, v62, v62 quad_perm:[2,3,0,1] row_mask:0xf bank_mask:0xf
    s_nop 1
    v_add_f32_dpp v62, v62, v62 row_half_mirror row_mask:0xf bank_mask:0xf
    s_nop 1
    v_add_f32_dpp v62, v62, v62 row_mirror row_mask:0xf bank_mask:0xf
    v_mov_b32 v64, v62
    s_nop 1
    v_permlane16_swap_b32 v62, v64
    v_add_f32 v62, v62, v64
    s_mov_b32 s64, 0x3acccccd
    s_mov_b32 s65, 0x3727c5ac
    v_mul_f32 v60, s64, v60
    v_mul_f32 v62, s64, v62
    v_fma_f32 v62, -v60, v60, v62
    v_max_f32 v62, 0, v62
    v_add_f32 v62, s65, v62
    v_rsq_f32 v62, v62
    s_nop 0
    v_mul_f32 v63, v60, v62
    v_max_f32 v62, 0x00800000, v62
    v_lshrrev_b32 v64, 5, v3
    v_lshlrev_b32 v64, 3, v64
    s_lshl_b32 s44, s2, 3
    s_lshl_b32 s45, s37, 1
    s_add_u32 s44, s44, s45
    s_lshl_b32 s86, s44, 3
    buffer_load_dword v249, v248, s[28:31], 0 offen sc1
    s_waitcnt vmcnt(22)
    s_barrier
    s_add_u32 m0, s60, s56
    s_nop 0
    buffer_load_dwordx4 v16, s[12:15], s61 offen offset:0 lds
    buffer_load_dwordx4 v17, s[12:15], s61 offen offset:1024 lds
    buffer_load_dwordx4 v18, s[12:15], s61 offen offset:2048 lds
    buffer_load_dwordx4 v19, s[12:15], s61 offen offset:3072 lds
    s_add_u32 m0, s63, s56
    s_nop 0
    buffer_load_dwordx4 v20, s[16:19], s62 offen offset:0 lds
    buffer_load_dwordx4 v21, s[16:19], s62 offen offset:1024 lds
    buffer_load_dwordx4 v22, s[16:19], s62 offen offset:2048 lds
    buffer_load_dwordx4 v23, s[16:19], s62 offen offset:3072 lds
    s_add_u32 s38, s38, 1
    s_cmp_eq_u32 s38, 10
    s_cselect_b32 s39, 1280, 0
    s_cselect_b32 s26, 2457600, 0
    s_cselect_b32 s38, 0, s38
    s_sub_u32 s61, s61, s39
    s_sub_u32 s62, s62, s26
    s_add_u32 s61, s61, 128
    s_add_u32 s62, s62, 245760
    s_add_u32 s56, s56, 32768
    s_and_b32 s56, s56, 0x1ffff
    s_waitcnt vmcnt(17)
    s_barrier
    s_add_u32 m0, s60, s56
    s_nop 0
    buffer_load_dwordx4 v16, s[12:15], s61 offen offset:0 lds
    buffer_load_dwordx4 v17, s[12:15], s61 offen offset:1024 lds
    buffer_load_dwordx4 v18, s[12:15], s61 offen offset:2048 lds
    buffer_load_dwordx4 v19, s[12:15], s61 offen offset:3072 lds
    s_add_u32 m0, s63, s56
    s_nop 0
    buffer_load_dwordx4 v20, s[16:19], s62 offen offset:0 lds
    buffer_load_dwordx4 v21, s[16:19], s62 offen offset:1024 lds
    buffer_load_dwordx4 v22, s[16:19], s62 offen offset:2048 lds
    buffer_load_dwordx4 v23, s[16:19], s62 offen offset:3072 lds
    s_add_u32 s38, s38, 1
    s_cmp_eq_u32 s38, 10
    s_cselect_b32 s39, 1280, 0
    s_cselect_b32 s26, 2457600, 0
    s_cselect_b32 s38, 0, s38
    s_sub_u32 s61, s61, s39
    s_sub_u32 s62, s62, s26
    s_add_u32 s61, s61, 128
    s_add_u32 s62, s62, 245760
    s_add_u32 s56, s56, 32768
    s_and_b32 s56, s56, 0x1ffff
    s_waitcnt vmcnt(17)
    s_barrier
    s_add_u32 m0, s60, s56
    s_nop 0
    buffer_load_dwordx4 v16, s[12:15], s61 offen offset:0 lds
    buffer_load_dwordx4 v17, s[12:15], s61 offen offset:1024 lds
    buffer_load_dwordx4 v18, s[12:15], s61 offen offset:2048 lds
    buffer_load_dwordx4 v19, s[12:15], s61 offen offset:3072 lds
    s_add_u32 m0, s63, s56
    s_nop 0
    buffer_load_dwordx4 v20, s[16:19], s62 offen offset:0 lds
    buffer_load_dwordx4 v21, s[16:19], s62 offen offset:1024 lds
    buffer_load_dwordx4 v22, s[16:19], s62 offen offset:2048 lds
    buffer_load_dwordx4 v23, s[16:19], s62 offen offset:3072 lds
    s_add_u32 s38, s38, 1
    s_cmp_eq_u32 s38, 10
    s_cselect_b32 s39, 1280, 0
    s_cselect_b32 s26, 2457600, 0
    s_cselect_b32 s38, 0, s38
    s_sub_u32 s61, s61, s39
    s_sub_u32 s62, s62, s26
    s_add_u32 s61, s61, 128
    s_add_u32 s62, s62, 245760
    s_add_u32 s56, s56, 32768
    s_and_b32 s56, s56, 0x1ffff
    s_waitcnt vmcnt(24)
    s_mov_b32 s74, 0
P1_WZ_Q:
    v_cmp_ne_u32 vcc, 1, v249
    s_add_u32 s74, s74, 1
    s_cbranch_vccz P1_WZD_Q
    s_cmp_gt_u32 s74, 400000
    s_cbranch_scc1 P1_WZD_Q
    buffer_load_dword v249, v248, s[28:31], 0 offen sc1
    s_waitcnt vmcnt(0)
    s_branch P1_WZ_Q
P1_WZD_Q:
    buffer_store_dwordx2 v[62:63], v64, s[48:51], s86 offen sc1
    s_waitcnt vmcnt(17)
    s_barrier
    s_add_u32 m0, s60, s56
    s_nop 0
    buffer_load_dwordx4 v16, s[12:15], s61 offen offset:0 lds
    buffer_load_dwordx4 v17, s[12:15], s61 offen offset:1024 lds
    buffer_load_dwordx4 v18, s[12:15], s61 offen offset:2048 lds
    buffer_load_dwordx4 v19, s[12:15], s61 offen offset:3072 lds
    s_add_u32 m0, s63, s56
    s_nop 0
    buffer_load_dwordx4 v20, s[16:19], s62 offen offset:0 lds
    buffer_load_dwordx4 v21, s[16:19], s62 offen offset:1024 lds
    buffer_load_dwordx4 v22, s[16:19], s62 offen offset:2048 lds
    buffer_load_dwordx4 v23, s[16:19], s62 offen offset:3072 lds
    s_add_u32 s38, s38, 1
    s_cmp_eq_u32 s38, 10
    s_cselect_b32 s39, 1280, 0
    s_cselect_b32 s26, 2457600, 0
    s_cselect_b32 s38, 0, s38
    s_sub_u32 s61, s61, s39
    s_sub_u32 s62, s62, s26
    s_add_u32 s61, s61, 128
    s_add_u32 s62, s62, 245760
    s_add_u32 s56, s56, 32768
    s_and_b32 s56, s56, 0x1ffff
    s_waitcnt vmcnt(17)
    s_barrier
    s_add_u32 m0, s60, s56
    s_nop 0
    buffer_load_dwordx4 v16, s[12:15], s61 offen offset:0 lds
    buffer_load_dwordx4 v17, s[12:15], s61 offen offset:1024 lds
    buffer_load_dwordx4 v18, s[12:15], s61 offen offset:2048 lds
    buffer_load_dwordx4 v19, s[12:15], s61 offen offset:3072 lds
    s_add_u32 m0, s63, s56
    s_nop 0
    buffer_load_dwordx4 v20, s[16:19], s62 offen offset:0 lds
    buffer_load_dwordx4 v21, s[16:19], s62 offen offset:1024 lds
    buffer_load_dwordx4 v22, s[16:19], s62 offen offset:2048 lds
    buffer_load_dwordx4 v23, s[16:19], s62 offen offset:3072 lds
    s_add_u32 s38, s38, 1
    s_cmp_eq_u32 s38, 10
    s_cselect_b32 s39, 1280, 0
    s_cselect_b32 s26, 2457600, 0
    s_cselect_b32 s38, 0, s38
    s_sub_u32 s61, s61, s39
    s_sub_u32 s62, s62, s26
    s_add_u32 s61, s61, 128
    s_add_u32 s62, s62, 245760
    s_add_u32 s56, s56, 32768
    s_and_b32 s56, s56, 0x1ffff
    s_waitcnt vmcnt(17)
    s_barrier
    buffer_load_dwordx2 v[60:61], v246, s[48:51], s87 offen sc1
    s_waitcnt vmcnt(9)
    s_barrier
    s_waitcnt vmcnt(1)
    s_barrier
    s_waitcnt vmcnt(0)
    s_mov_b32 s74, 0
P1_FS_Q:
    v_cmp_eq_u32 vcc, 0, v60
    s_nop 3
    s_and_b64 vcc, vcc, s[46:47]
    s_add_u32 s74, s74, 1
    s_cbranch_vccz P1_FSD_Q
    s_cmp_gt_u32 s74, 400000
    s_cbranch_scc1 P1_FSD_Q
    buffer_load_dwordx2 v[60:61], v246, s[48:51], s87 offen sc1
    s_waitcnt vmcnt(0)
    s_branch P1_FS_Q
P1_FSD_Q:
    v_add_u32 v27, 65536, v246
    ds_write_b64 v27, v[60:61]
    s_barrier
    s_waitcnt lgkmcnt(0)
    s_barrier
    s_endpgm
P1_QC:
    s_waitcnt lgkmcnt(0)
    s_mov_b32 s40, s10
    s_mov_b32 s41, s11
    s_mov_b32 s42, 0x10000
    s_mov_b32 s43, 0x20000
    s_mov_b32 s66, 0x358637bd
    s_mov_b32 s67, 0x358637bd
    s_mov_b32 s68, 0x3fb8aa3b
    s_mov_b32 s69, 0x3fb8aa3b
    v_mov_b32 v250, 0xb5c1a2a0
    v_mov_b32 v251, 0xb5c1a2a0
    v_and_b32 v26, 7, v4
    v_xor_b32 v26, v26, v5
    v_lshlrev_b32 v26, 4, v26
    v_lshl_add_u32 v26, v4, 7, v26
    s_mul_i32 s44, s38, 8192
    v_add_u32 v32, s44, v26
    v_xor_b32 v33, 64, v32
    v_lshl_add_u32 v26, v5, 3, v6
    v_lshlrev_b32 v26, 8, v26
    v_lshl_add_u32 v26, v7, 3, v26
    v_and_b32 v27, 1, v5
    v_lshl_add_u32 v27, v27, 2, v6
    v_lshl_add_u32 v26, v27, 5, v26
    s_mov_b32 s46, 0x3334
    s_lshl_b32 s44, s38, 1
    s_add_u32 s44, s44, 0
    s_and_b32 s44, s44, 3
    s_lshl_b32 s45, s39, 2
    s_add_u32 s44, s44, s45
    s_mov_b32 s76, s44
    s_lshl_b32 s45, s44, 5
    v_xor_b32 v36, s45, v26
    s_lshl_b32 s45, s35, 5
    s_lshl_b32 s47, s44, 2
    s_add_u32 s45, s45, s47
    v_add_u32 v31, s45, v5
    v_mul_lo_u32 v27, v31, s46
    v_lshrrev_b32 v27, 16, v27
    v_mul_u32_u24 v28, 5, v27
    v_sub_u32 v28, v31, v28
    v_lshrrev_b32 v29, 3, v27
    v_mul_u32_u24 v29, 5120, v29
    v_bfe_u32 v30, v27, 1, 2
    v_and_b32 v27, 1, v27
    v_lshlrev_b32 v31, 10, v30
    v_lshl_add_u32 v31, v28, 8, v31
    v_lshl_add_u32 v31, v27, 3, v31
    v_and_b32 v24, 1, v30
    v_lshl_add_u32 v24, v24, 1, v27
    v_lshlrev_b32 v24, 8, v24
    v_lshrrev_b32 v30, 1, v30
    v_lshl_add_u32 v24, v30, 3, v24
    v_add_u32 v24, 4096, v24
    v_cmp_gt_u32 vcc, 4, v28
    s_nop 1
    v_cndmask_b32 v30, v24, v31, vcc
    v_add_u32 v29, v29, v30
    v_lshl_add_u32 v44, v4, 4, v29
    s_lshl_b32 s44, s38, 1
    s_add_u32 s44, s44, 1
    s_and_b32 s44, s44, 3
    s_lshl_b32 s45, s39, 2
    s_add_u32 s44, s44, s45
    s_mov_b32 s77, s44
    s_lshl_b32 s45, s44, 5
    v_xor_b32 v37, s45, v26
    s_lshl_b32 s45, s35, 5
    s_lshl_b32 s47, s44, 2
    s_add_u32 s45, s45, s47
    v_add_u32 v31, s45, v5
    v_mul_lo_u32 v27, v31, s46
    v_lshrrev_b32 v27, 16, v27
    v_mul_u32_u24 v28, 5, v27
    v_sub_u32 v28, v31, v28
    v_lshrrev_b32 v29, 3, v27
    v_mul_u32_u24 v29, 5120, v29
    v_bfe_u32 v30, v27, 1, 2
    v_and_b32 v27, 1, v27
    v_lshlrev_b32 v31, 10, v30
    v_lshl_add_u32 v31, v28, 8, v31
    v_lshl_add_u32 v31, v27, 3, v31
    v_and_b32 v24, 1, v30
    v_lshl_add_u32 v24, v24, 1, v27
    v_lshlrev_b32 v24, 8, v24
    v_lshrrev_b32 v30, 1, v30
    v_lshl_add_u32 v24, v30, 3, v24
    v_add_u32 v24, 4096, v24
    v_cmp_gt_u32 vcc, 4, v28
    s_nop 1
    v_cndmask_b32 v30, v24, v31, vcc
    v_add_u32 v29, v29, v30
    v_lshl_add_u32 v45, v4, 4, v29
    s_lshl_b32 s44, s38, 1
    s_add_u32 s44, s44, 2
    s_and_b32 s44, s44, 3
    s_lshl_b32 s45, s39, 2
    s_add_u32 s44, s44, s45
    s_mov_b32 s78, s44
    s_lshl_b32 s45, s44, 5
    v_xor_b32 v38, s45, v26
    s_lshl_b32 s45, s35, 5
    s_lshl_b32 s47, s44, 2
    s_add_u32 s45, s45, s47
    v_add_u32 v31, s45, v5
    v_mul_lo_u32 v27, v31, s46
    v_lshrrev_b32 v27, 16, v27
    v_mul_u32_u24 v28, 5, v27
    v_sub_u32 v28, v31, v28
    v_lshrrev_b32 v29, 3, v27
    v_mul_u32_u24 v29, 5120, v29
    v_bfe_u32 v30, v27, 1, 2
    v_and_b32 v27, 1, v27
    v_lshlrev_b32 v31, 10, v30
    v_lshl_add_u32 v31, v28, 8, v31
    v_lshl_add_u32 v31, v27, 3, v31
    v_and_b32 v24, 1, v30
    v_lshl_add_u32 v24, v24, 1, v27
    v_lshlrev_b32 v24, 8, v24
    v_lshrrev_b32 v30, 1, v30
    v_lshl_add_u32 v24, v30, 3, v24
    v_add_u32 v24, 4096, v24
    v_cmp_gt_u32 vcc, 4, v28
    s_nop 1
    v_cndmask_b32 v30, v24, v31, vcc
    v_add_u32 v29, v29, v30
    v_lshl_add_u32 v46, v4, 4, v29
    s_lshl_b32 s44, s38, 1
    s_add_u32 s44, s44, 3
    s_and_b32 s44, s44, 3
    s_lshl_b32 s45, s39, 2
    s_add_u32 s44, s44, s45
    s_mov_b32 s79, s44
    s_lshl_b32 s45, s44, 5
    v_xor_b32 v39, s45, v26
    s_lshl_b32 s45, s35, 5
    s_lshl_b32 s47, s44, 2
    s_add_u32 s45, s45, s47
    v_add_u32 v31, s45, v5
    v_mul_lo_u32 v27, v31, s46
    v_lshrrev_b32 v27, 16, v27
    v_mul_u32_u24 v28, 5, v27
    v_sub_u32 v28, v31, v28
    v_lshrrev_b32 v29, 3, v27
    v_mul_u32_u24 v29, 5120, v29
    v_bfe_u32 v30, v27, 1, 2
    v_and_b32 v27, 1, v27
    v_lshlrev_b32 v31, 10, v30
    v_lshl_add_u32 v31, v28, 8, v31
    v_lshl_add_u32 v31, v27, 3, v31
    v_and_b32 v24, 1, v30
    v_lshl_add_u32 v24, v24, 1, v27
    v_lshlrev_b32 v24, 8, v24
    v_lshrrev_b32 v30, 1, v30
    v_lshl_add_u32 v24, v30, 3, v24
    v_add_u32 v24, 4096, v24
    v_cmp_gt_u32 vcc, 4, v28
    s_nop 1
    v_cndmask_b32 v30, v24, v31, vcc
    v_add_u32 v29, v29, v30
    v_lshl_add_u32 v47, v4, 4, v29
    s_add_u32 s48, s10, 0x40000
    s_addc_u32 s49, s11, 0
    s_mov_b32 s50, 0x280000
    s_mov_b32 s51, 0x20000
    v_mov_b32 v116, 0
    v_mov_b32 v117, 0
    v_mov_b32 v118, 0
    v_mov_b32 v119, 0
    v_mov_b32 v120, 0
    v_mov_b32 v121, 0
    v_mov_b32 v122, 0
    v_mov_b32 v123, 0
    v_mov_b32 v124, 0
    v_mov_b32 v125, 0
    v_mov_b32 v126, 0
    v_mov_b32 v127, 0
    v_mov_b32 v128, 0
    v_mov_b32 v129, 0
    v_mov_b32 v130, 0
    v_mov_b32 v131, 0
    v_mov_b32 v132, 0
    v_mov_b32 v133, 0
    v_mov_b32 v134, 0
    v_mov_b32 v135, 0
    v_mov_b32 v136, 0
    v_mov_b32 v137, 0
    v_mov_b32 v138, 0
    v_mov_b32 v139, 0
    v_mov_b32 v140, 0
    v_mov_b32 v141, 0
    v_mov_b32 v142, 0
    v_mov_b32 v143, 0
    v_mov_b32 v144, 0
    v_mov_b32 v145, 0
    v_mov_b32 v146, 0
    v_mov_b32 v147, 0
    v_mov_b32 v148, 0
    v_mov_b32 v149, 0
    v_mov_b32 v150, 0
    v_mov_b32 v151, 0
    v_mov_b32 v152, 0
    v_mov_b32 v153, 0
    v_mov_b32 v154, 0
    v_mov_b32 v155, 0
    v_mov_b32 v156, 0
    v_mov_b32 v157, 0
    v_mov_b32 v158, 0
    v_mov_b32 v159, 0
    v_mov_b32 v160, 0
    v_mov_b32 v161, 0
    v_mov_b32 v162, 0
    v_mov_b32 v163, 0
    v_mov_b32 v164, 0
    v_mov_b32 v165, 0
    v_mov_b32 v166, 0
    v_mov_b32 v167, 0
    v_mov_b32 v168, 0
    v_mov_b32 v169, 0
    v_mov_b32 v170, 0
    v_mov_b32 v171, 0
    v_mov_b32 v172, 0
    v_mov_b32 v173, 0
    v_mov_b32 v174, 0
    v_mov_b32 v175, 0
    v_mov_b32 v176, 0
    v_mov_b32 v177, 0
    v_mov_b32 v178, 0
    v_mov_b32 v179, 0
    v_mov_b32 v180, 0
    v_mov_b32 v181, 0
    v_mov_b32 v182, 0
    v_mov_b32 v183, 0
    v_mov_b32 v184, 0
    v_mov_b32 v185, 0
    v_mov_b32 v186, 0
    v_mov_b32 v187, 0
    s_mov_b32 s59, 0
    s_barrier
    ds_read_b64_tr_b16 v[84:85], v36 offset:16384
    ds_read_b64_tr_b16 v[86:87], v36 offset:17408
    ds_read_b128 v[52:55], v32 offset:0
    ds_read_b64_tr_b16 v[88:89], v37 offset:16384
    ds_read_b64_tr_b16 v[90:91], v37 offset:17408
    ds_read_b128 v[56:59], v32 offset:2048
    ds_read_b64_tr_b16 v[92:93], v38 offset:16384
    ds_read_b64_tr_b16 v[94:95], v38 offset:17408
    ds_read_b128 v[60:63], v32 offset:4096
    ds_read_b64_tr_b16 v[96:97], v39 offset:16384
    ds_read_b64_tr_b16 v[98:99], v39 offset:17408
    ds_read_b128 v[64:67], v32 offset:6144
P1_CL_Q:
    s_waitcnt lgkmcnt(0)
    v_mfma_f32_16x16x32_bf16 v[116:119], v[84:87], v[52:55], v[116:119]
    ds_read_b64_tr_b16 v[100:101], v36 offset:24576
    ds_read_b64_tr_b16 v[102:103], v36 offset:25600
    v_mfma_f32_16x16x32_bf16 v[132:135], v[84:87], v[56:59], v[132:135]
    ds_read_b128 v[68:71], v33 offset:0
    ds_read_b64_tr_b16 v[104:105], v37 offset:24576
    v_mfma_f32_16x16x32_bf16 v[148:151], v[84:87], v[60:63], v[148:151]
    ds_read_b64_tr_b16 v[106:107], v37 offset:25600
    ds_read_b128 v[72:75], v33 offset:2048
    v_mfma_f32_16x16x32_bf16 v[164:167], v[84:87], v[64:67], v[164:167]
    ds_read_b64_tr_b16 v[108:109], v38 offset:24576
    ds_read_b64_tr_b16 v[110:111], v38 offset:25600
    v_mfma_f32_16x16x32_bf16 v[180:183], v[84:87], v[12:15], v[180:183]
    ds_read_b128 v[76:79], v33 offset:4096
    ds_read_b64_tr_b16 v[112:113], v39 offset:24576
    v_mfma_f32_16x16x32_bf16 v[120:123], v[88:91], v[52:55], v[120:123]
    ds_read_b64_tr_b16 v[114:115], v39 offset:25600
    ds_read_b128 v[80:83], v33 offset:6144
    v_mfma_f32_16x16x32_bf16 v[136:139], v[88:91], v[56:59], v[136:139]
    v_mfma_f32_16x16x32_bf16 v[152:155], v[88:91], v[60:63], v[152:155]
    v_mfma_f32_16x16x32_bf16 v[168:171], v[88:91], v[64:67], v[168:171]
    v_mfma_f32_16x16x32_bf16 v[184:187], v[88:91], v[12:15], v[184:187]
    v_mfma_f32_16x16x32_bf16 v[124:127], v[92:95], v[52:55], v[124:127]
    v_mfma_f32_16x16x32_bf16 v[140:143], v[92:95], v[56:59], v[140:143]
    v_mfma_f32_16x16x32_bf16 v[156:159], v[92:95], v[60:63], v[156:159]
    v_mfma_f32_16x16x32_bf16 v[172:175], v[92:95], v[64:67], v[172:175]
    v_mfma_f32_16x16x32_bf16 v[128:131], v[96:99], v[52:55], v[128:131]
    v_mfma_f32_16x16x32_bf16 v[144:147], v[96:99], v[56:59], v[144:147]
    v_mfma_f32_16x16x32_bf16 v[160:163], v[96:99], v[60:63], v[160:163]
    v_mfma_f32_16x16x32_bf16 v[176:179], v[96:99], v[64:67], v[176:179]
    s_waitcnt lgkmcnt(0)
    s_barrier
    v_mfma_f32_16x16x32_bf16 v[116:119], v[100:103], v[68:71], v[116:119]
    ds_read_b64_tr_b16 v[84:85], v36 offset:49152
    ds_read_b64_tr_b16 v[86:87], v36 offset:50176
    v_mfma_f32_16x16x32_bf16 v[132:135], v[100:103], v[72:75], v[132:135]
    ds_read_b128 v[52:55], v32 offset:32768
    ds_read_b64_tr_b16 v[88:89], v37 offset:49152
    v_mfma_f32_16x16x32_bf16 v[148:151], v[100:103], v[76:79], v[148:151]
    ds_read_b64_tr_b16 v[90:91], v37 offset:50176
    ds_read_b128 v[56:59], v32 offset:34816
    v_mfma_f32_16x16x32_bf16 v[164:167], v[100:103], v[80:83], v[164:167]
    ds_read_b64_tr_b16 v[92:93], v38 offset:49152
    ds_read_b64_tr_b16 v[94:95], v38 offset:50176
    v_mfma_f32_16x16x32_bf16 v[180:183], v[100:103], v[12:15], v[180:183]
    ds_read_b128 v[60:63], v32 offset:36864
    ds_read_b64_tr_b16 v[96:97], v39 offset:49152
    v_mfma_f32_16x16x32_bf16 v[120:123], v[104:107], v[68:71], v[120:123]
    ds_read_b64_tr_b16 v[98:99], v39 offset:50176
    ds_read_b128 v[64:67], v32 offset:38912
    v_mfma_f32_16x16x32_bf16 v[136:139], v[104:107], v[72:75], v[136:139]
    v_mfma_f32_16x16x32_bf16 v[152:155], v[104:107], v[76:79], v[152:155]
    v_mfma_f32_16x16x32_bf16 v[168:171], v[104:107], v[80:83], v[168:171]
    v_mfma_f32_16x16x32_bf16 v[184:187], v[104:107], v[12:15], v[184:187]
    v_mfma_f32_16x16x32_bf16 v[124:127], v[108:111], v[68:71], v[124:127]
    v_mfma_f32_16x16x32_bf16 v[140:143], v[108:111], v[72:75], v[140:143]
    v_mfma_f32_16x16x32_bf16 v[156:159], v[108:111], v[76:79], v[156:159]
    v_mfma_f32_16x16x32_bf16 v[172:175], v[108:111], v[80:83], v[172:175]
    v_mfma_f32_16x16x32_bf16 v[128:131], v[112:115], v[68:71], v[128:131]
    v_mfma_f32_16x16x32_bf16 v[144:147], v[112:115], v[72:75], v[144:147]
    v_mfma_f32_16x16x32_bf16 v[160:163], v[112:115], v[76:79], v[160:163]
    v_mfma_f32_16x16x32_bf16 v[176:179], v[112:115], v[80:83], v[176:179]
    s_waitcnt lgkmcnt(0)
    v_mfma_f32_16x16x32_bf16 v[116:119], v[84:87], v[52:55], v[116:119]
    ds_read_b64_tr_b16 v[100:101], v36 offset:57344
    ds_read_b64_tr_b16 v[102:103], v36 offset:58368
    v_mfma_f32_16x16x32_bf16 v[132:135], v[84:87], v[56:59], v[132:135]
    ds_read_b128 v[68:71], v33 offset:32768
    ds_read_b64_tr_b16 v[104:105], v37 offset:57344
    v_mfma_f32_16x16x32_bf16 v[148:151], v[84:87], v[60:63], v[148:151]
    ds_read_b64_tr_b16 v[106:107], v37 offset:58368
    ds_read_b128 v[72:75], v33 offset:34816
    v_mfma_f32_16x16x32_bf16 v[164:167], v[84:87], v[64:67], v[164:167]
    ds_read_b64_tr_b16 v[108:109], v38 offset:57344
    ds_read_b64_tr_b16 v[110:111], v38 offset:58368
    v_mfma_f32_16x16x32_bf16 v[180:183], v[84:87], v[12:15], v[180:183]
    ds_read_b128 v[76:79], v33 offset:36864
    ds_read_b64_tr_b16 v[112:113], v39 offset:57344
    v_mfma_f32_16x16x32_bf16 v[120:123], v[88:91], v[52:55], v[120:123]
    ds_read_b64_tr_b16 v[114:115], v39 offset:58368
    ds_read_b128 v[80:83], v33 offset:38912
    v_mfma_f32_16x16x32_bf16 v[136:139], v[88:91], v[56:59], v[136:139]
    v_mfma_f32_16x16x32_bf16 v[152:155], v[88:91], v[60:63], v[152:155]
    v_mfma_f32_16x16x32_bf16 v[168:171], v[88:91], v[64:67], v[168:171]
    v_mfma_f32_16x16x32_bf16 v[184:187], v[88:91], v[12:15], v[184:187]
    v_mfma_f32_16x16x32_bf16 v[124:127], v[92:95], v[52:55], v[124:127]
    v_mfma_f32_16x16x32_bf16 v[140:143], v[92:95], v[56:59], v[140:143]
    v_mfma_f32_16x16x32_bf16 v[156:159], v[92:95], v[60:63], v[156:159]
    v_mfma_f32_16x16x32_bf16 v[172:175], v[92:95], v[64:67], v[172:175]
    v_mfma_f32_16x16x32_bf16 v[128:131], v[96:99], v[52:55], v[128:131]
    v_mfma_f32_16x16x32_bf16 v[144:147], v[96:99], v[56:59], v[144:147]
    v_mfma_f32_16x16x32_bf16 v[160:163], v[96:99], v[60:63], v[160:163]
    v_mfma_f32_16x16x32_bf16 v[176:179], v[96:99], v[64:67], v[176:179]
    s_waitcnt lgkmcnt(0)
    s_barrier
    v_xor_b32 v32, 0x10000, v32
    v_xor_b32 v33, 0x10000, v33
    v_xor_b32 v36, 0x10000, v36
    v_xor_b32 v37, 0x10000, v37
    v_xor_b32 v38, 0x10000, v38
    v_xor_b32 v39, 0x10000, v39
    v_mfma_f32_16x16x32_bf16 v[116:119], v[100:103], v[68:71], v[116:119]
    ds_read_b64_tr_b16 v[84:85], v36 offset:16384
    ds_read_b64_tr_b16 v[86:87], v36 offset:17408
    v_mfma_f32_16x16x32_bf16 v[132:135], v[100:103], v[72:75], v[132:135]
    ds_read_b128 v[52:55], v32 offset:0
    ds_read_b64_tr_b16 v[88:89], v37 offset:16384
    v_mfma_f32_16x16x32_bf16 v[148:151], v[100:103], v[76:79], v[148:151]
    ds_read_b64_tr_b16 v[90:91], v37 offset:17408
    ds_read_b128 v[56:59], v32 offset:2048
    v_mfma_f32_16x16x32_bf16 v[164:167], v[100:103], v[80:83], v[164:167]
    ds_read_b64_tr_b16 v[92:93], v38 offset:16384
    ds_read_b64_tr_b16 v[94:95], v38 offset:17408
    v_mfma_f32_16x16x32_bf16 v[180:183], v[100:103], v[12:15], v[180:183]
    ds_read_b128 v[60:63], v32 offset:4096
    ds_read_b64_tr_b16 v[96:97], v39 offset:16384
    v_mfma_f32_16x16x32_bf16 v[120:123], v[104:107], v[68:71], v[120:123]
    ds_read_b64_tr_b16 v[98:99], v39 offset:17408
    ds_read_b128 v[64:67], v32 offset:6144
    v_mfma_f32_16x16x32_bf16 v[136:139], v[104:107], v[72:75], v[136:139]
    v_mfma_f32_16x16x32_bf16 v[152:155], v[104:107], v[76:79], v[152:155]
    v_mfma_f32_16x16x32_bf16 v[168:171], v[104:107], v[80:83], v[168:171]
    v_mfma_f32_16x16x32_bf16 v[184:187], v[104:107], v[12:15], v[184:187]
    v_mfma_f32_16x16x32_bf16 v[124:127], v[108:111], v[68:71], v[124:127]
    v_mfma_f32_16x16x32_bf16 v[140:143], v[108:111], v[72:75], v[140:143]
    v_mfma_f32_16x16x32_bf16 v[156:159], v[108:111], v[76:79], v[156:159]
    v_mfma_f32_16x16x32_bf16 v[172:175], v[108:111], v[80:83], v[172:175]
    v_mfma_f32_16x16x32_bf16 v[128:131], v[112:115], v[68:71], v[128:131]
    v_mfma_f32_16x16x32_bf16 v[144:147], v[112:115], v[72:75], v[144:147]
    v_mfma_f32_16x16x32_bf16 v[160:163], v[112:115], v[76:79], v[160:163]
    v_mfma_f32_16x16x32_bf16 v[176:179], v[112:115], v[80:83], v[176:179]
    s_add_u32 s59, s59, 1
    s_cmp_lt_u32 s59, 5
    s_cbranch_scc1 P1_CL_Q
    s_waitcnt lgkmcnt(0)
    s_setprio 0
    v_lshlrev_b32 v26, 4, v5
    v_add_u32 v26, 66560, v26
    s_lshl_b32 s44, s76, 6
    v_add_u32 v27, s44, v26
    ds_write_b128 v27, v[180:183]
    s_lshl_b32 s44, s77, 6
    v_add_u32 v27, s44, v26
    ds_write_b128 v27, v[184:187]
    s_waitcnt lgkmcnt(0)
    s_barrier
    s_lshl_b32 s44, s78, 6
    v_add_u32 v27, s44, v26
    ds_read_b128 v[188:191], v27
    s_lshl_b32 s44, s79, 6
    v_add_u32 v27, s44, v26
    ds_read_b128 v[192:195], v27
    v_lshlrev_b32 v26, 3, v4
    s_mul_i32 s44, s38, 512
    s_add_u32 s44, s44, 65536
    v_add_u32 v26, s44, v26
    ds_read_b64 v[204:205], v26 offset:0
    ds_read_b64 v[206:207], v26 offset:128
    ds_read_b64 v[208:209], v26 offset:256
    ds_read_b64 v[210:211], v26 offset:384
    s_lshl_b32 s44, s34, 3
    s_lshl_b32 s45, s38, 2
    s_add_u32 s44, s44, s45
    s_mul_i32 s44, s44, 20480
    s_waitcnt lgkmcnt(0)
    v_pk_fma_f32 v[212:213], v[180:181], v[204:205], s[66:67] op_sel:[0,1,0] op_sel_hi:[1,1,1] neg_lo:[1,0,0] neg_hi:[1,0,0]
    v_pk_fma_f32 v[214:215], v[182:183], v[204:205], s[66:67] op_sel:[0,1,0] op_sel_hi:[1,1,1] neg_lo:[1,0,0] neg_hi:[1,0,0]
    v_pk_fma_f32 v[216:217], v[184:185], v[204:205], s[66:67] op_sel:[0,1,0] op_sel_hi:[1,1,1] neg_lo:[1,0,0] neg_hi:[1,0,0]
    v_pk_fma_f32 v[218:219], v[186:187], v[204:205], s[66:67] op_sel:[0,1,0] op_sel_hi:[1,1,1] neg_lo:[1,0,0] neg_hi:[1,0,0]
    v_pk_fma_f32 v[220:221], v[188:189], v[204:205], s[66:67] op_sel:[0,1,0] op_sel_hi:[1,1,1] neg_lo:[1,0,0] neg_hi:[1,0,0]
    v_pk_fma_f32 v[222:223], v[190:191], v[204:205], s[66:67] op_sel:[0,1,0] op_sel_hi:[1,1,1] neg_lo:[1,0,0] neg_hi:[1,0,0]
    v_pk_fma_f32 v[224:225], v[192:193], v[204:205], s[66:67] op_sel:[0,1,0] op_sel_hi:[1,1,1] neg_lo:[1,0,0] neg_hi:[1,0,0]
    v_pk_fma_f32 v[226:227], v[194:195], v[204:205], s[66:67] op_sel:[0,1,0] op_sel_hi:[1,1,1] neg_lo:[1,0,0] neg_hi:[1,0,0]
    v_pk_fma_f32 v[116:117], v[116:117], v[204:205], v[212:213] op_sel:[0,0,0] op_sel_hi:[1,0,1]
    v_pk_fma_f32 v[118:119], v[118:119], v[204:205], v[214:215] op_sel:[0,0,0] op_sel_hi:[1,0,1]
    v_pk_fma_f32 v[120:121], v[120:121], v[204:205], v[216:217] op_sel:[0,0,0] op_sel_hi:[1,0,1]
    v_pk_fma_f32 v[122:123], v[122:123], v[204:205], v[218:219] op_sel:[0,0,0] op_sel_hi:[1,0,1]
    v_pk_fma_f32 v[124:125], v[124:125], v[204:205], v[220:221] op_sel:[0,0,0] op_sel_hi:[1,0,1]
    v_pk_fma_f32 v[126:127], v[126:127], v[204:205], v[222:223] op_sel:[0,0,0] op_sel_hi:[1,0,1]
    v_pk_fma_f32 v[128:129], v[128:129], v[204:205], v[224:225] op_sel:[0,0,0] op_sel_hi:[1,0,1]
    v_pk_fma_f32 v[130:131], v[130:131], v[204:205], v[226:227] op_sel:[0,0,0] op_sel_hi:[1,0,1]
    v_pk_fma_f32 v[212:213], v[116:117], s[68:69], v[250:251]
    v_pk_fma_f32 v[214:215], v[118:119], s[68:69], v[250:251]
    v_pk_fma_f32 v[216:217], v[120:121], s[68:69], v[250:251]
    v_pk_fma_f32 v[218:219], v[122:123], s[68:69], v[250:251]
    v_pk_fma_f32 v[220:221], v[124:125], s[68:69], v[250:251]
    v_pk_fma_f32 v[222:223], v[126:127], s[68:69], v[250:251]
    v_pk_fma_f32 v[224:225], v[128:129], s[68:69], v[250:251]
    v_pk_fma_f32 v[226:227], v[130:131], s[68:69], v[250:251]
    v_exp_f32 v212, v212 clamp
    v_exp_f32 v213, v213 clamp
    v_exp_f32 v214, v214 clamp
    v_exp_f32 v215, v215 clamp
    v_exp_f32 v216, v216 clamp
    v_exp_f32 v217, v217 clamp
    v_exp_f32 v218, v218 clamp
    v_exp_f32 v219, v219 clamp
    v_exp_f32 v220, v220 clamp
    v_exp_f32 v221, v221 clamp
    v_exp_f32 v222, v222 clamp
    v_exp_f32 v223, v223 clamp
    v_exp_f32 v224, v224 clamp
    v_exp_f32 v225, v225 clamp
    v_exp_f32 v226, v226 clamp
    v_exp_f32 v227, v227 clamp
    v_max_f32 v116, s66, v116
    v_max_f32 v117, s66, v117
    v_max_f32 v118, s66, v118
    v_max_f32 v119, s66, v119
    v_max_f32 v120, s66, v120
    v_max_f32 v121, s66, v121
    v_max_f32 v122, s66, v122
    v_max_f32 v123, s66, v123
    v_max_f32 v124, s66, v124
    v_max_f32 v125, s66, v125
    v_max_f32 v126, s66, v126
    v_max_f32 v127, s66, v127
    v_max_f32 v128, s66, v128
    v_max_f32 v129, s66, v129
    v_max_f32 v130, s66, v130
    v_max_f32 v131, s66, v131
    v_pk_add_f32 v[116:117], v[116:117], v[212:213]
    v_pk_add_f32 v[118:119], v[118:119], v[214:215]
    v_pk_add_f32 v[120:121], v[120:121], v[216:217]
    v_pk_add_f32 v[122:123], v[122:123], v[218:219]
    v_pk_add_f32 v[124:125], v[124:125], v[220:221]
    v_pk_add_f32 v[126:127], v[126:127], v[222:223]
    v_pk_add_f32 v[128:129], v[128:129], v[224:225]
    v_pk_add_f32 v[130:131], v[130:131], v[226:227]
    v_cvt_pk_bf16_f32 v116, v116, v117
    v_cvt_pk_bf16_f32 v117, v118, v119
    buffer_store_dwordx2 v[116:117], v44, s[48:51], s44 offen sc1
    v_cvt_pk_bf16_f32 v120, v120, v121
    v_cvt_pk_bf16_f32 v121, v122, v123
    buffer_store_dwordx2 v[120:121], v45, s[48:51], s44 offen sc1
    v_cvt_pk_bf16_f32 v124, v124, v125
    v_cvt_pk_bf16_f32 v125, v126, v127
    buffer_store_dwordx2 v[124:125], v46, s[48:51], s44 offen sc1
    v_cvt_pk_bf16_f32 v128, v128, v129
    v_cvt_pk_bf16_f32 v129, v130, v131
    buffer_store_dwordx2 v[128:129], v47, s[48:51], s44 offen sc1
    s_add_u32 s44, s44, 20480
    v_pk_fma_f32 v[212:213], v[180:181], v[206:207], s[66:67] op_sel:[0,1,0] op_sel_hi:[1,1,1] neg_lo:[1,0,0] neg_hi:[1,0,0]
    v_pk_fma_f32 v[214:215], v[182:183], v[206:207], s[66:67] op_sel:[0,1,0] op_sel_hi:[1,1,1] neg_lo:[1,0,0] neg_hi:[1,0,0]
    v_pk_fma_f32 v[216:217], v[184:185], v[206:207], s[66:67] op_sel:[0,1,0] op_sel_hi:[1,1,1] neg_lo:[1,0,0] neg_hi:[1,0,0]
    v_pk_fma_f32 v[218:219], v[186:187], v[206:207], s[66:67] op_sel:[0,1,0] op_sel_hi:[1,1,1] neg_lo:[1,0,0] neg_hi:[1,0,0]
    v_pk_fma_f32 v[220:221], v[188:189], v[206:207], s[66:67] op_sel:[0,1,0] op_sel_hi:[1,1,1] neg_lo:[1,0,0] neg_hi:[1,0,0]
    v_pk_fma_f32 v[222:223], v[190:191], v[206:207], s[66:67] op_sel:[0,1,0] op_sel_hi:[1,1,1] neg_lo:[1,0,0] neg_hi:[1,0,0]
    v_pk_fma_f32 v[224:225], v[192:193], v[206:207], s[66:67] op_sel:[0,1,0] op_sel_hi:[1,1,1] neg_lo:[1,0,0] neg_hi:[1,0,0]
    v_pk_fma_f32 v[226:227], v[194:195], v[206:207], s[66:67] op_sel:[0,1,0] op_sel_hi:[1,1,1] neg_lo:[1,0,0] neg_hi:[1,0,0]
    v_pk_fma_f32 v[132:133], v[132:133], v[206:207], v[212:213] op_sel:[0,0,0] op_sel_hi:[1,0,1]
    v_pk_fma_f32 v[134:135], v[134:135], v[206:207], v[214:215] op_sel:[0,0,0] op_sel_hi:[1,0,1]
    v_pk_fma_f32 v[136:137], v[136:137], v[206:207], v[216:217] op_sel:[0,0,0] op_sel_hi:[1,0,1]
    v_pk_fma_f32 v[138:139], v[138:139], v[206:207], v[218:219] op_sel:[0,0,0] op_sel_hi:[1,0,1]
    v_pk_fma_f32 v[140:141], v[140:141], v[206:207], v[220:221] op_sel:[0,0,0] op_sel_hi:[1,0,1]
    v_pk_fma_f32 v[142:143], v[142:143], v[206:207], v[222:223] op_sel:[0,0,0] op_sel_hi:[1,0,1]
    v_pk_fma_f32 v[144:145], v[144:145], v[206:207], v[224:225] op_sel:[0,0,0] op_sel_hi:[1,0,1]
    v_pk_fma_f32 v[146:147], v[146:147], v[206:207], v[226:227] op_sel:[0,0,0] op_sel_hi:[1,0,1]
    v_pk_fma_f32 v[212:213], v[132:133], s[68:69], v[250:251]
    v_pk_fma_f32 v[214:215], v[134:135], s[68:69], v[250:251]
    v_pk_fma_f32 v[216:217], v[136:137], s[68:69], v[250:251]
    v_pk_fma_f32 v[218:219], v[138:139], s[68:69], v[250:251]
    v_pk_fma_f32 v[220:221], v[140:141], s[68:69], v[250:251]
    v_pk_fma_f32 v[222:223], v[142:143], s[68:69], v[250:251]
    v_pk_fma_f32 v[224:225], v[144:145], s[68:69], v[250:251]
    v_pk_fma_f32 v[226:227], v[146:147], s[68:69], v[250:251]
    v_exp_f32 v212, v212 clamp
    v_exp_f32 v213, v213 clamp
    v_exp_f32 v214, v214 clamp
    v_exp_f32 v215, v215 clamp
    v_exp_f32 v216, v216 clamp
    v_exp_f32 v217, v217 clamp
    v_exp_f32 v218, v218 clamp
    v_exp_f32 v219, v219 clamp
    v_exp_f32 v220, v220 clamp
    v_exp_f32 v221, v221 clamp
    v_exp_f32 v222, v222 clamp
    v_exp_f32 v223, v223 clamp
    v_exp_f32 v224, v224 clamp
    v_exp_f32 v225, v225 clamp
    v_exp_f32 v226, v226 clamp
    v_exp_f32 v227, v227 clamp
    v_max_f32 v132, s66, v132
    v_max_f32 v133, s66, v133
    v_max_f32 v134, s66, v134
    v_max_f32 v135, s66, v135
    v_max_f32 v136, s66, v136
    v_max_f32 v137, s66, v137
    v_max_f32 v138, s66, v138
    v_max_f32 v139, s66, v139
    v_max_f32 v140, s66, v140
    v_max_f32 v141, s66, v141
    v_max_f32 v142, s66, v142
    v_max_f32 v143, s66, v143
    v_max_f32 v144, s66, v144
    v_max_f32 v145, s66, v145
    v_max_f32 v146, s66, v146
    v_max_f32 v147, s66, v147
    v_pk_add_f32 v[132:133], v[132:133], v[212:213]
    v_pk_add_f32 v[134:135], v[134:135], v[214:215]
    v_pk_add_f32 v[136:137], v[136:137], v[216:217]
    v_pk_add_f32 v[138:139], v[138:139], v[218:219]
    v_pk_add_f32 v[140:141], v[140:141], v[220:221]
    v_pk_add_f32 v[142:143], v[142:143], v[222:223]
    v_pk_add_f32 v[144:145], v[144:145], v[224:225]
    v_pk_add_f32 v[146:147], v[146:147], v[226:227]
    v_cvt_pk_bf16_f32 v132, v132, v133
    v_cvt_pk_bf16_f32 v133, v134, v135
    buffer_store_dwordx2 v[132:133], v44, s[48:51], s44 offen sc1
    v_cvt_pk_bf16_f32 v136, v136, v137
    v_cvt_pk_bf16_f32 v137, v138, v139
    buffer_store_dwordx2 v[136:137], v45, s[48:51], s44 offen sc1
    v_cvt_pk_bf16_f32 v140, v140, v141
    v_cvt_pk_bf16_f32 v141, v142, v143
    buffer_store_dwordx2 v[140:141], v46, s[48:51], s44 offen sc1
    v_cvt_pk_bf16_f32 v144, v144, v145
    v_cvt_pk_bf16_f32 v145, v146, v147
    buffer_store_dwordx2 v[144:145], v47, s[48:51], s44 offen sc1
    s_add_u32 s44, s44, 20480
    v_pk_fma_f32 v[212:213], v[180:181], v[208:209], s[66:67] op_sel:[0,1,0] op_sel_hi:[1,1,1] neg_lo:[1,0,0] neg_hi:[1,0,0]
    v_pk_fma_f32 v[214:215], v[182:183], v[208:209], s[66:67] op_sel:[0,1,0] op_sel_hi:[1,1,1] neg_lo:[1,0,0] neg_hi:[1,0,0]
    v_pk_fma_f32 v[216:217], v[184:185], v[208:209], s[66:67] op_sel:[0,1,0] op_sel_hi:[1,1,1] neg_lo:[1,0,0] neg_hi:[1,0,0]
    v_pk_fma_f32 v[218:219], v[186:187], v[208:209], s[66:67] op_sel:[0,1,0] op_sel_hi:[1,1,1] neg_lo:[1,0,0] neg_hi:[1,0,0]
    v_pk_fma_f32 v[220:221], v[188:189], v[208:209], s[66:67] op_sel:[0,1,0] op_sel_hi:[1,1,1] neg_lo:[1,0,0] neg_hi:[1,0,0]
    v_pk_fma_f32 v[222:223], v[190:191], v[208:209], s[66:67] op_sel:[0,1,0] op_sel_hi:[1,1,1] neg_lo:[1,0,0] neg_hi:[1,0,0]
    v_pk_fma_f32 v[224:225], v[192:193], v[208:209], s[66:67] op_sel:[0,1,0] op_sel_hi:[1,1,1] neg_lo:[1,0,0] neg_hi:[1,0,0]
    v_pk_fma_f32 v[226:227], v[194:195], v[208:209], s[66:67] op_sel:[0,1,0] op_sel_hi:[1,1,1] neg_lo:[1,0,0] neg_hi:[1,0,0]
    v_pk_fma_f32 v[148:149], v[148:149], v[208:209], v[212:213] op_sel:[0,0,0] op_sel_hi:[1,0,1]
    v_pk_fma_f32 v[150:151], v[150:151], v[208:209], v[214:215] op_sel:[0,0,0] op_sel_hi:[1,0,1]
    v_pk_fma_f32 v[152:153], v[152:153], v[208:209], v[216:217] op_sel:[0,0,0] op_sel_hi:[1,0,1]
    v_pk_fma_f32 v[154:155], v[154:155], v[208:209], v[218:219] op_sel:[0,0,0] op_sel_hi:[1,0,1]
    v_pk_fma_f32 v[156:157], v[156:157], v[208:209], v[220:221] op_sel:[0,0,0] op_sel_hi:[1,0,1]
    v_pk_fma_f32 v[158:159], v[158:159], v[208:209], v[222:223] op_sel:[0,0,0] op_sel_hi:[1,0,1]
    v_pk_fma_f32 v[160:161], v[160:161], v[208:209], v[224:225] op_sel:[0,0,0] op_sel_hi:[1,0,1]
    v_pk_fma_f32 v[162:163], v[162:163], v[208:209], v[226:227] op_sel:[0,0,0] op_sel_hi:[1,0,1]
    v_pk_fma_f32 v[212:213], v[148:149], s[68:69], v[250:251]
    v_pk_fma_f32 v[214:215], v[150:151], s[68:69], v[250:251]
    v_pk_fma_f32 v[216:217], v[152:153], s[68:69], v[250:251]
    v_pk_fma_f32 v[218:219], v[154:155], s[68:69], v[250:251]
    v_pk_fma_f32 v[220:221], v[156:157], s[68:69], v[250:251]
    v_pk_fma_f32 v[222:223], v[158:159], s[68:69], v[250:251]
    v_pk_fma_f32 v[224:225], v[160:161], s[68:69], v[250:251]
    v_pk_fma_f32 v[226:227], v[162:163], s[68:69], v[250:251]
    v_exp_f32 v212, v212 clamp
    v_exp_f32 v213, v213 clamp
    v_exp_f32 v214, v214 clamp
    v_exp_f32 v215, v215 clamp
    v_exp_f32 v216, v216 clamp
    v_exp_f32 v217, v217 clamp
    v_exp_f32 v218, v218 clamp
    v_exp_f32 v219, v219 clamp
    v_exp_f32 v220, v220 clamp
    v_exp_f32 v221, v221 clamp
    v_exp_f32 v222, v222 clamp
    v_exp_f32 v223, v223 clamp
    v_exp_f32 v224, v224 clamp
    v_exp_f32 v225, v225 clamp
    v_exp_f32 v226, v226 clamp
    v_exp_f32 v227, v227 clamp
    v_max_f32 v148, s66, v148
    v_max_f32 v149, s66, v149
    v_max_f32 v150, s66, v150
    v_max_f32 v151, s66, v151
    v_max_f32 v152, s66, v152
    v_max_f32 v153, s66, v153
    v_max_f32 v154, s66, v154
    v_max_f32 v155, s66, v155
    v_max_f32 v156, s66, v156
    v_max_f32 v157, s66, v157
    v_max_f32 v158, s66, v158
    v_max_f32 v159, s66, v159
    v_max_f32 v160, s66, v160
    v_max_f32 v161, s66, v161
    v_max_f32 v162, s66, v162
    v_max_f32 v163, s66, v163
    v_pk_add_f32 v[148:149], v[148:149], v[212:213]
    v_pk_add_f32 v[150:151], v[150:151], v[214:215]
    v_pk_add_f32 v[152:153], v[152:153], v[216:217]
    v_pk_add_f32 v[154:155], v[154:155], v[218:219]
    v_pk_add_f32 v[156:157], v[156:157], v[220:221]
    v_pk_add_f32 v[158:159], v[158:159], v[222:223]
    v_pk_add_f32 v[160:161], v[160:161], v[224:225]
    v_pk_add_f32 v[162:163], v[162:163], v[226:227]
    v_cvt_pk_bf16_f32 v148, v148, v149
    v_cvt_pk_bf16_f32 v149, v150, v151
    buffer_store_dwordx2 v[148:149], v44, s[48:51], s44 offen sc1
    v_cvt_pk_bf16_f32 v152, v152, v153
    v_cvt_pk_bf16_f32 v153, v154, v155
    buffer_store_dwordx2 v[152:153], v45, s[48:51], s44 offen sc1
    v_cvt_pk_bf16_f32 v156, v156, v157
    v_cvt_pk_bf16_f32 v157, v158, v159
    buffer_store_dwordx2 v[156:157], v46, s[48:51], s44 offen sc1
    v_cvt_pk_bf16_f32 v160, v160, v161
    v_cvt_pk_bf16_f32 v161, v162, v163
    buffer_store_dwordx2 v[160:161], v47, s[48:51], s44 offen sc1
    s_add_u32 s44, s44, 20480
    v_pk_fma_f32 v[212:213], v[180:181], v[210:211], s[66:67] op_sel:[0,1,0] op_sel_hi:[1,1,1] neg_lo:[1,0,0] neg_hi:[1,0,0]
    v_pk_fma_f32 v[214:215], v[182:183], v[210:211], s[66:67] op_sel:[0,1,0] op_sel_hi:[1,1,1] neg_lo:[1,0,0] neg_hi:[1,0,0]
    v_pk_fma_f32 v[216:217], v[184:185], v[210:211], s[66:67] op_sel:[0,1,0] op_sel_hi:[1,1,1] neg_lo:[1,0,0] neg_hi:[1,0,0]
    v_pk_fma_f32 v[218:219], v[186:187], v[210:211], s[66:67] op_sel:[0,1,0] op_sel_hi:[1,1,1] neg_lo:[1,0,0] neg_hi:[1,0,0]
    v_pk_fma_f32 v[220:221], v[188:189], v[210:211], s[66:67] op_sel:[0,1,0] op_sel_hi:[1,1,1] neg_lo:[1,0,0] neg_hi:[1,0,0]
    v_pk_fma_f32 v[222:223], v[190:191], v[210:211], s[66:67] op_sel:[0,1,0] op_sel_hi:[1,1,1] neg_lo:[1,0,0] neg_hi:[1,0,0]
    v_pk_fma_f32 v[224:225], v[192:193], v[210:211], s[66:67] op_sel:[0,1,0] op_sel_hi:[1,1,1] neg_lo:[1,0,0] neg_hi:[1,0,0]
    v_pk_fma_f32 v[226:227], v[194:195], v[210:211], s[66:67] op_sel:[0,1,0] op_sel_hi:[1,1,1] neg_lo:[1,0,0] neg_hi:[1,0,0]
    v_pk_fma_f32 v[164:165], v[164:165], v[210:211], v[212:213] op_sel:[0,0,0] op_sel_hi:[1,0,1]
    v_pk_fma_f32 v[166:167], v[166:167], v[210:211], v[214:215] op_sel:[0,0,0] op_sel_hi:[1,0,1]
    v_pk_fma_f32 v[168:169], v[168:169], v[210:211], v[216:217] op_sel:[0,0,0] op_sel_hi:[1,0,1]
    v_pk_fma_f32 v[170:171], v[170:171], v[210:211], v[218:219] op_sel:[0,0,0] op_sel_hi:[1,0,1]
    v_pk_fma_f32 v[172:173], v[172:173], v[210:211], v[220:221] op_sel:[0,0,0] op_sel_hi:[1,0,1]
    v_pk_fma_f32 v[174:175], v[174:175], v[210:211], v[222:223] op_sel:[0,0,0] op_sel_hi:[1,0,1]
    v_pk_fma_f32 v[176:177], v[176:177], v[210:211], v[224:225] op_sel:[0,0,0] op_sel_hi:[1,0,1]
    v_pk_fma_f32 v[178:179], v[178:179], v[210:211], v[226:227] op_sel:[0,0,0] op_sel_hi:[1,0,1]
    v_pk_fma_f32 v[212:213], v[164:165], s[68:69], v[250:251]
    v_pk_fma_f32 v[214:215], v[166:167], s[68:69], v[250:251]
    v_pk_fma_f32 v[216:217], v[168:169], s[68:69], v[250:251]
    v_pk_fma_f32 v[218:219], v[170:171], s[68:69], v[250:251]
    v_pk_fma_f32 v[220:221], v[172:173], s[68:69], v[250:251]
    v_pk_fma_f32 v[222:223], v[174:175], s[68:69], v[250:251]
    v_pk_fma_f32 v[224:225], v[176:177], s[68:69], v[250:251]
    v_pk_fma_f32 v[226:227], v[178:179], s[68:69], v[250:251]
    v_exp_f32 v212, v212 clamp
    v_exp_f32 v213, v213 clamp
    v_exp_f32 v214, v214 clamp
    v_exp_f32 v215, v215 clamp
    v_exp_f32 v216, v216 clamp
    v_exp_f32 v217, v217 clamp
    v_exp_f32 v218, v218 clamp
    v_exp_f32 v219, v219 clamp
    v_exp_f32 v220, v220 clamp
    v_exp_f32 v221, v221 clamp
    v_exp_f32 v222, v222 clamp
    v_exp_f32 v223, v223 clamp
    v_exp_f32 v224, v224 clamp
    v_exp_f32 v225, v225 clamp
    v_exp_f32 v226, v226 clamp
    v_exp_f32 v227, v227 clamp
    v_max_f32 v164, s66, v164
    v_max_f32 v165, s66, v165
    v_max_f32 v166, s66, v166
    v_max_f32 v167, s66, v167
    v_max_f32 v168, s66, v168
    v_max_f32 v169, s66, v169
    v_max_f32 v170, s66, v170
    v_max_f32 v171, s66, v171
    v_max_f32 v172, s66, v172
    v_max_f32 v173, s66, v173
    v_max_f32 v174, s66, v174
    v_max_f32 v175, s66, v175
    v_max_f32 v176, s66, v176
    v_max_f32 v177, s66, v177
    v_max_f32 v178, s66, v178
    v_max_f32 v179, s66, v179
    v_pk_add_f32 v[164:165], v[164:165], v[212:213]
    v_pk_add_f32 v[166:167], v[166:167], v[214:215]
    v_pk_add_f32 v[168:169], v[168:169], v[216:217]
    v_pk_add_f32 v[170:171], v[170:171], v[218:219]
    v_pk_add_f32 v[172:173], v[172:173], v[220:221]
    v_pk_add_f32 v[174:175], v[174:175], v[222:223]
    v_pk_add_f32 v[176:177], v[176:177], v[224:225]
    v_pk_add_f32 v[178:179], v[178:179], v[226:227]
    v_cvt_pk_bf16_f32 v164, v164, v165
    v_cvt_pk_bf16_f32 v165, v166, v167
    buffer_store_dwordx2 v[164:165], v44, s[48:51], s44 offen sc1
    v_cvt_pk_bf16_f32 v168, v168, v169
    v_cvt_pk_bf16_f32 v169, v170, v171
    buffer_store_dwordx2 v[168:169], v45, s[48:51], s44 offen sc1
    v_cvt_pk_bf16_f32 v172, v172, v173
    v_cvt_pk_bf16_f32 v173, v174, v175
    buffer_store_dwordx2 v[172:173], v46, s[48:51], s44 offen sc1
    v_cvt_pk_bf16_f32 v176, v176, v177
    v_cvt_pk_bf16_f32 v177, v178, v179
    buffer_store_dwordx2 v[176:177], v47, s[48:51], s44 offen sc1
P1_END:
    s_endpgm

.p2align 8
.globl k2_kernel
.type k2_kernel,@function
k2_kernel:
    s_cmp_ge_u32 s2, 256
    s_cbranch_scc1 K2_END
    s_load_dwordx2 s[6:7], s[0:1], 80
    s_load_dwordx2 s[8:9], s[0:1], 0
    s_load_dwordx2 s[10:11], s[0:1], 40
    s_load_dwordx2 s[4:5], s[0:1], 64
    s_load_dwordx2 s[24:25], s[0:1], 56
    s_and_b32 s32, s2, 7
    s_lshr_b32 s33, s2, 3
    s_lshr_b32 s37, s32, 1
    s_and_b32 s38, s32, 1
    s_and_b32 s34, s33, 7
    s_lshl_b32 s39, s37, 3
    s_add_u32 s34, s34, s39
    s_lshr_b32 s35, s33, 3
    s_lshl_b32 s39, s38, 2
    s_add_u32 s35, s35, s39
    s_and_b32 s64, s33, 3
    s_lshl_b32 s39, s37, 2
    s_add_u32 s64, s64, s39
    s_lshr_b32 s65, s33, 2
    s_lshl_b32 s39, s38, 3
    s_add_u32 s65, s65, s39
    v_lshrrev_b32 v2, 6, v0
    v_and_b32 v3, 63, v0
    v_readfirstlane_b32 s36, v2
    v_lshlrev_b32 v1, 4, v3
    v_lshlrev_b32 v4, 3, v3
    v_add_u32 v7, 4096, v1
    s_lshl_b32 s39, s34, 4
    s_add_u32 s39, s39, s36
    s_mul_i32 s39, s39, 5120
    s_add_u32 s66, s36, 0
    s_and_b32 s66, s66, 3
    s_mul_i32 s66, s66, 20480
    s_add_u32 s40, s66, s39
    s_add_u32 s66, s36, 1
    s_and_b32 s66, s66, 3
    s_mul_i32 s66, s66, 20480
    s_add_u32 s41, s66, s39
    s_add_u32 s66, s36, 2
    s_and_b32 s66, s66, 3
    s_mul_i32 s66, s66, 20480
    s_add_u32 s42, s66, s39
    s_add_u32 s66, s36, 3
    s_and_b32 s66, s66, 3
    s_mul_i32 s66, s66, 20480
    s_add_u32 s43, s66, s39
    s_mul_i32 s39, s35, 100
    s_mul_i32 s67, s36, 5
    s_add_u32 s66, s39, s67
    s_lshl_b32 s44, s66, 10
    s_add_u32 s45, s44, 20480
    s_add_u32 s46, s44, 40960
    s_add_u32 s47, s44, 61440
    s_add_u32 s48, s44, 81920
    s_mul_i32 s49, s36, 13440
    s_mul_i32 s50, s36, 14336
    s_add_u32 s50, s50, 98304
    s_lshl_b32 s51, s34, 2
    s_add_u32 s51, s51, s36
    s_waitcnt lgkmcnt(0)
    s_mov_b32 s12, s6
    s_mov_b32 s13, s7
    s_mov_b32 s14, 0xd200
    s_mov_b32 s15, 0x20000
    s_add_u32 m0, s50, 0
    s_add_u32 s66, s49, 0
    buffer_load_dwordx4 v1, s[12:15], s66 offen offset:0 lds
    buffer_load_dwordx4 v1, s[12:15], s66 offen offset:1024 lds
    buffer_load_dwordx4 v1, s[12:15], s66 offen offset:2048 lds
    buffer_load_dwordx4 v1, s[12:15], s66 offen offset:3072 lds
    s_add_u32 m0, s50, 4096
    s_add_u32 s66, s49, 4096
    buffer_load_dwordx4 v1, s[12:15], s66 offen offset:0 lds
    buffer_load_dwordx4 v1, s[12:15], s66 offen offset:1024 lds
    buffer_load_dwordx4 v1, s[12:15], s66 offen offset:2048 lds
    buffer_load_dwordx4 v1, s[12:15], s66 offen offset:3072 lds
    s_add_u32 m0, s50, 8192
    s_add_u32 s66, s49, 8192
    buffer_load_dwordx4 v1, s[12:15], s66 offen offset:0 lds
    buffer_load_dwordx4 v1, s[12:15], s66 offen offset:1024 lds
    buffer_load_dwordx4 v1, s[12:15], s66 offen offset:2048 lds
    buffer_load_dwordx4 v1, s[12:15], s66 offen offset:3072 lds
    s_add_u32 m0, s50, 12288
    s_add_u32 s66, s49, 12288
    buffer_load_dwordx4 v1, s[12:15], s66 offen offset:0 lds
    buffer_load_dwordx4 v1, s[12:15], s66 offen offset:1024 lds
    s_add_u32 s16, s6, 0x40000
    s_addc_u32 s17, s7, 0
    s_mov_b32 s18, 0x280000
    s_mov_b32 s19, 0x20000
    s_add_u32 s20, s6, 0xb40000
    s_addc_u32 s21, s7, 0
    s_mov_b32 s22, 0xc8000
    s_mov_b32 s23, 0x20000
    buffer_load_dwordx4 a[2:5], v1, s[16:19], s40 offen offset:0
    buffer_load_dwordx4 a[8:11], v1, s[16:19], s40 offen offset:1024
    buffer_load_dwordx4 a[16:19], v1, s[16:19], s40 offen offset:2048
    buffer_load_dwordx4 a[22:25], v1, s[16:19], s40 offen offset:3072
    buffer_load_dwordx4 v[72:75], v7, s[16:19], s40 offen
    buffer_load_dwordx4 a[112:115], v1, s[20:23], s44 offen offset:0
    buffer_load_dwordx4 a[132:135], v1, s[20:23], s45 offen offset:0
    buffer_load_dwordx4 a[152:155], v1, s[20:23], s46 offen offset:0
    buffer_load_dwordx4 a[172:175], v1, s[20:23], s47 offen offset:0
    buffer_load_dwordx4 a[192:195], v1, s[20:23], s48 offen offset:0
    buffer_load_dwordx4 a[116:119], v1, s[20:23], s44 offen offset:1024
    buffer_load_dwordx4 a[136:139], v1, s[20:23], s45 offen offset:1024
    buffer_load_dwordx4 a[156:159], v1, s[20:23], s46 offen offset:1024
    s_add_u32 s28, s6, 0x2c0000
    s_addc_u32 s29, s7, 0
    s_mov_b32 s30, 0x280000
    s_mov_b32 s31, 0x20000
    s_add_u32 s52, s6, 0x10000
    s_addc_u32 s53, s7, 0
    s_mov_b32 s54, 0x20000
    s_mov_b32 s55, 0x20000
    s_add_u32 s56, s6, 0xc10000
    s_addc_u32 s57, s7, 0
    s_mov_b32 s58, 0x1e0000
    s_mov_b32 s59, 0x20000
    s_add_u32 s60, s6, 0x38000
    s_addc_u32 s61, s7, 0
    s_mov_b32 s62, 0x6000
    s_mov_b32 s63, 0x20000
    s_add_u32 s26, s6, 0x38000
    s_addc_u32 s27, s7, 0
    s_mov_b32 s76, s8
    s_mov_b32 s77, s9
    s_mov_b32 s78, 0x280000
    s_mov_b32 s79, 0x20000
    s_lshr_b32 s68, s51, 1
    s_lshl_b32 s68, s68, 7
    s_lshl_b32 s69, s64, 2
    s_add_u32 s69, s69, s36
    s_lshl_b32 s69, s69, 7
    s_lshl_b32 s70, s64, 1
    s_lshr_b32 s39, s36, 1
    s_add_u32 s70, s70, s39
    s_lshl_b32 s70, s70, 2
    s_lshr_b32 s39, s65, 2
    s_add_u32 s70, s70, s39
    s_lshl_b32 s70, s70, 7
    s_add_u32 s70, s70, 8192
    s_lshl_b32 s71, s34, 2
    s_add_u32 s71, s71, s36
    s_lshl_b32 s71, s71, 7
    s_add_u32 s71, s71, 8192
    s_mul_i32 s72, s65, 122880
    s_lshl_b32 s66, s36, 10
    s_add_u32 s72, s72, s66
    s_mul_i32 s80, s36, 6144
    v_and_b32 v224, 15, v3
    v_lshrrev_b32 v225, 4, v3
    v_mul_u32_u24 v226, 80, v224
    v_add_u32 v226, s50, v226
    v_add_u32 v227, 64, v226
    v_lshl_add_u32 v226, v225, 4, v226
    v_and_b32 v192, 3, v224
    v_lshrrev_b32 v193, 2, v224
    v_add_u32 v193, 16, v193
    v_cmp_eq_u32 vcc, 0, v192
    v_mov_b32 v194, 20
    s_nop 0
    v_cndmask_b32 v193, v194, v193, vcc
    v_mul_u32_u24 v228, 80, v193
    v_add_u32 v228, s50, v228
    v_add_u32 v229, 64, v228
    v_lshl_add_u32 v228, v225, 4, v228
    v_cmp_gt_u32 vcc, 2, v192
    s_nop 1
    v_cndmask_b32 v232, 0, -1, vcc
    v_cmp_eq_u32 vcc, 0, v225
    s_nop 1
    v_cndmask_b32 v230, 0, -1, vcc
    v_and_b32 v233, v230, v232
    v_cmp_eq_u32 vcc, 1, v225
    s_nop 1
    v_cndmask_b32 v231, 0, -1, vcc
    v_and_b32 v234, v231, v232
    v_cmp_eq_u32 vcc, 2, v225
    s_nop 1
    v_cndmask_b32 v250, 0, -1, vcc
    v_and_b32 v252, v250, v232
    v_cmp_eq_u32 vcc, 3, v225
    s_nop 1
    v_cndmask_b32 v251, 0, -1, vcc
    v_and_b32 v253, v251, v232
    v_mov_b32 v236, 0
    v_mov_b32 v237, 0x358637bd
    v_mov_b32 v238, 0
    v_mov_b32 v239, 0
    v_mul_u32_u24 v2, 1280, v224
    v_lshl_add_u32 v2, v225, 3, v2
    s_mul_i32 s73, s51, 20480
    s_mul_i32 s39, s35, 160
    s_add_u32 s73, s73, s39
    s_waitcnt vmcnt(13)
    ds_read_b128 v[8:11], v226 offset:0
    ds_read_b128 v[12:15], v227 offset:0
    ds_read_b128 v[16:19], v228 offset:0
    ds_read_b128 v[20:23], v229 offset:0
    ds_read_b128 v[24:27], v226 offset:1680
    ds_read_b128 v[28:31], v227 offset:1680
    ds_read_b128 v[32:35], v228 offset:1680
    ds_read_b128 v[36:39], v229 offset:1680
    ds_read_b128 v[40:43], v226 offset:3360
    ds_read_b128 v[44:47], v227 offset:3360
    ds_read_b128 v[48:51], v228 offset:3360
    ds_read_b128 v[52:55], v229 offset:3360
    ds_read_b128 v[56:59], v226 offset:5040
    ds_read_b128 v[60:63], v227 offset:5040
    ds_read_b128 v[64:67], v228 offset:5040
    ds_read_b128 v[68:71], v229 offset:5040
    s_waitcnt lgkmcnt(12)
    v_cvt_pk_bf16_f32 v90, v8, v9
    v_cvt_pk_bf16_f32 v91, v10, v11
    v_cvt_pk_bf16_f32 v88, v12, v13
    v_cvt_pk_bf16_f32 v89, v14, v15
    v_cvt_pk_bf16_f32 v94, v16, v17
    v_cvt_pk_bf16_f32 v95, v18, v19
    v_cvt_pk_bf16_f32 v92, v20, v21
    buffer_load_dwordx4 a[176:179], v1, s[20:23], s47 offen offset:1024
    v_cvt_pk_bf16_f32 v93, v22, v23
    v_and_b32 v88, v88, v230
    v_and_b32 v94, v94, v232
    v_and_b32 v92, v92, v233
    v_and_b32 v89, v89, v230
    v_and_b32 v95, v95, v232
    v_and_b32 v93, v93, v233
    buffer_load_dwordx4 a[196:199], v1, s[20:23], s48 offen offset:1024
    ds_read_b128 v[8:11], v226 offset:6720
    ds_read_b128 v[12:15], v227 offset:6720
    ds_read_b128 v[16:19], v228 offset:6720
    ds_read_b128 v[20:23], v229 offset:6720
    s_waitcnt lgkmcnt(12)
    v_cvt_pk_bf16_f32 v96, v24, v25
    v_cvt_pk_bf16_f32 v97, v26, v27
    v_cvt_pk_bf16_f32 v98, v28, v29
    v_cvt_pk_bf16_f32 v99, v30, v31
    v_cvt_pk_bf16_f32 v100, v32, v33
    v_cvt_pk_bf16_f32 v101, v34, v35
    v_cvt_pk_bf16_f32 v102, v36, v37
    buffer_load_dwordx4 a[120:123], v1, s[20:23], s44 offen offset:2048
    v_cvt_pk_bf16_f32 v103, v38, v39
    v_and_b32 v98, v98, v231
    v_and_b32 v100, v100, v232
    v_and_b32 v102, v102, v234
    v_and_b32 v99, v99, v231
    v_and_b32 v101, v101, v232
    v_and_b32 v103, v103, v234
    buffer_load_dwordx4 a[140:143], v1, s[20:23], s45 offen offset:2048
    ds_read_b128 v[24:27], v226 offset:8400
    ds_read_b128 v[28:31], v227 offset:8400
    ds_read_b128 v[32:35], v228 offset:8400
    ds_read_b128 v[36:39], v229 offset:8400
    s_waitcnt lgkmcnt(12)
    v_cvt_pk_bf16_f32 v106, v40, v41
    v_cvt_pk_bf16_f32 v107, v42, v43
    v_cvt_pk_bf16_f32 v104, v44, v45
    v_cvt_pk_bf16_f32 v105, v46, v47
    v_cvt_pk_bf16_f32 v110, v48, v49
    v_cvt_pk_bf16_f32 v111, v50, v51
    v_cvt_pk_bf16_f32 v108, v52, v53
    buffer_load_dwordx4 a[160:163], v1, s[20:23], s46 offen offset:2048
    v_cvt_pk_bf16_f32 v109, v54, v55
    v_and_b32 v104, v104, v250
    v_and_b32 v110, v110, v232
    v_and_b32 v108, v108, v252
    v_and_b32 v105, v105, v250
    v_and_b32 v111, v111, v232
    v_and_b32 v109, v109, v252
    buffer_load_dwordx4 a[180:183], v1, s[20:23], s47 offen offset:2048
    ds_read_b128 v[40:43], v226 offset:10080
    ds_read_b128 v[44:47], v227 offset:10080
    ds_read_b128 v[48:51], v228 offset:10080
    ds_read_b128 v[52:55], v229 offset:10080
    s_waitcnt lgkmcnt(12)
    v_cvt_pk_bf16_f32 v112, v56, v57
    v_cvt_pk_bf16_f32 v113, v58, v59
    v_cvt_pk_bf16_f32 v114, v60, v61
    v_cvt_pk_bf16_f32 v115, v62, v63
    v_cvt_pk_bf16_f32 v116, v64, v65
    v_cvt_pk_bf16_f32 v117, v66, v67
    v_cvt_pk_bf16_f32 v118, v68, v69
    buffer_load_dwordx4 a[200:203], v1, s[20:23], s48 offen offset:2048
    v_cvt_pk_bf16_f32 v119, v70, v71
    v_and_b32 v114, v114, v251
    v_and_b32 v116, v116, v232
    v_and_b32 v118, v118, v253
    v_and_b32 v115, v115, v251
    v_and_b32 v117, v117, v232
    v_and_b32 v119, v119, v253
    buffer_load_dwordx4 a[124:127], v1, s[20:23], s44 offen offset:3072
    ds_read_b128 v[56:59], v226 offset:11760
    ds_read_b128 v[60:63], v227 offset:11760
    ds_read_b128 v[64:67], v228 offset:11760
    ds_read_b128 v[68:71], v229 offset:11760
    s_waitcnt lgkmcnt(12)
    v_cvt_pk_bf16_f32 v122, v8, v9
    v_cvt_pk_bf16_f32 v123, v10, v11
    v_cvt_pk_bf16_f32 v120, v12, v13
    v_cvt_pk_bf16_f32 v121, v14, v15
    v_cvt_pk_bf16_f32 v126, v16, v17
    v_cvt_pk_bf16_f32 v127, v18, v19
    v_cvt_pk_bf16_f32 v124, v20, v21
    buffer_load_dwordx4 a[144:147], v1, s[20:23], s45 offen offset:3072
    v_cvt_pk_bf16_f32 v125, v22, v23
    v_and_b32 v120, v120, v230
    v_and_b32 v126, v126, v232
    v_and_b32 v124, v124, v233
    v_and_b32 v121, v121, v230
    v_and_b32 v127, v127, v232
    v_and_b32 v125, v125, v233
    buffer_load_dwordx4 a[164:167], v1, s[20:23], s46 offen offset:3072
    s_waitcnt lgkmcnt(8)
    v_cvt_pk_bf16_f32 v128, v24, v25
    v_cvt_pk_bf16_f32 v129, v26, v27
    v_cvt_pk_bf16_f32 v130, v28, v29
    v_cvt_pk_bf16_f32 v131, v30, v31
    v_cvt_pk_bf16_f32 v132, v32, v33
    v_cvt_pk_bf16_f32 v133, v34, v35
    v_cvt_pk_bf16_f32 v134, v36, v37
    buffer_load_dwordx4 a[184:187], v1, s[20:23], s47 offen offset:3072
    v_cvt_pk_bf16_f32 v135, v38, v39
    v_and_b32 v130, v130, v231
    v_and_b32 v132, v132, v232
    v_and_b32 v134, v134, v234
    v_and_b32 v131, v131, v231
    v_and_b32 v133, v133, v232
    v_and_b32 v135, v135, v234
    buffer_load_dwordx4 a[204:207], v1, s[20:23], s48 offen offset:3072
    s_waitcnt lgkmcnt(4)
    v_cvt_pk_bf16_f32 v138, v40, v41
    v_cvt_pk_bf16_f32 v139, v42, v43
    v_cvt_pk_bf16_f32 v136, v44, v45
    v_cvt_pk_bf16_f32 v137, v46, v47
    v_cvt_pk_bf16_f32 v142, v48, v49
    v_cvt_pk_bf16_f32 v143, v50, v51
    v_cvt_pk_bf16_f32 v140, v52, v53
    buffer_load_dwordx4 a[128:131], v7, s[20:23], s44 offen
    v_cvt_pk_bf16_f32 v141, v54, v55
    v_and_b32 v136, v136, v250
    v_and_b32 v142, v142, v232
    v_and_b32 v140, v140, v252
    v_and_b32 v137, v137, v250
    v_and_b32 v143, v143, v232
    v_and_b32 v141, v141, v252
    buffer_load_dwordx4 a[148:151], v7, s[20:23], s45 offen
    s_waitcnt lgkmcnt(0)
    v_cvt_pk_bf16_f32 v144, v56, v57
    v_cvt_pk_bf16_f32 v145, v58, v59
    v_cvt_pk_bf16_f32 v146, v60, v61
    v_cvt_pk_bf16_f32 v147, v62, v63
    v_cvt_pk_bf16_f32 v148, v64, v65
    buffer_load_dwordx4 a[168:171], v7, s[20:23], s46 offen
    v_cvt_pk_bf16_f32 v149, v66, v67
    v_cvt_pk_bf16_f32 v150, v68, v69
    v_cvt_pk_bf16_f32 v151, v70, v71
    v_and_b32 v146, v146, v251
    v_and_b32 v148, v148, v232
    buffer_load_dwordx4 a[188:191], v7, s[20:23], s47 offen
    v_and_b32 v150, v150, v253
    v_and_b32 v147, v147, v251
    v_and_b32 v149, v149, v232
    v_and_b32 v151, v151, v253
    buffer_load_dwordx4 a[208:211], v7, s[20:23], s48 offen
    s_barrier
    v_accvgpr_write_b32 a212, v120
    v_accvgpr_write_b32 a213, v121
    v_accvgpr_write_b32 a214, v122
    v_accvgpr_write_b32 a215, v123
    v_accvgpr_write_b32 a216, v124
    v_accvgpr_write_b32 a217, v125
    v_accvgpr_write_b32 a218, v126
    v_accvgpr_write_b32 a219, v127
    v_accvgpr_write_b32 a220, v128
    v_accvgpr_write_b32 a221, v129
    v_accvgpr_write_b32 a222, v130
    v_accvgpr_write_b32 a223, v131
    v_accvgpr_write_b32 a224, v132
    v_accvgpr_write_b32 a225, v133
    v_accvgpr_write_b32 a226, v134
    v_accvgpr_write_b32 a227, v135
    v_accvgpr_write_b32 a228, v136
    v_accvgpr_write_b32 a229, v137
    v_accvgpr_write_b32 a230, v138
    v_accvgpr_write_b32 a231, v139
    v_accvgpr_write_b32 a232, v140
    v_accvgpr_write_b32 a233, v141
    v_accvgpr_write_b32 a234, v142
    v_accvgpr_write_b32 a235, v143
    v_accvgpr_write_b32 a236, v144
    v_accvgpr_write_b32 a237, v145
    v_accvgpr_write_b32 a238, v146
    v_accvgpr_write_b32 a239, v147
    v_accvgpr_write_b32 a240, v148
    v_accvgpr_write_b32 a241, v149
    v_accvgpr_write_b32 a242, v150
    v_accvgpr_write_b32 a243, v151
    s_waitcnt vmcnt(25)
    v_accvgpr_write_b32 a0, v72
    v_accvgpr_write_b32 a1, v73
    v_accvgpr_write_b32 a6, v72
    v_accvgpr_write_b32 a7, v73
    v_accvgpr_write_b32 a12, v72
    v_accvgpr_write_b32 a13, v73
    v_accvgpr_write_b32 a14, v74
    v_accvgpr_write_b32 a15, v75
    v_accvgpr_write_b32 a20, v74
    v_accvgpr_write_b32 a21, v75
    v_accvgpr_write_b32 a26, v74
    v_accvgpr_write_b32 a27, v75
    v_mfma_f32_16x16x32_bf16 v[192:195], v[88:91], a[0:3], 0
    v_mfma_f32_16x16x32_bf16 v[196:199], v[92:95], a[0:3], v[236:239]
    buffer_load_dwordx4 a[30:33], v1, s[16:19], s41 offen offset:0
    v_mfma_f32_16x16x32_bf16 v[200:203], v[96:99], a[4:7], 0
    v_mfma_f32_16x16x32_bf16 v[204:207], v[100:103], a[4:7], v[236:239]
    buffer_load_dwordx4 a[36:39], v1, s[16:19], s41 offen offset:1024
    v_mfma_f32_16x16x32_bf16 v[208:211], v[104:107], a[6:9], 0
    buffer_load_dwordx4 a[44:47], v1, s[16:19], s41 offen offset:2048
    v_mfma_f32_16x16x32_bf16 v[212:215], v[108:111], a[6:9], v[236:239]
    v_mfma_f32_16x16x32_bf16 v[216:219], v[112:115], a[10:13], 0
    buffer_load_dwordx4 a[50:53], v1, s[16:19], s41 offen offset:3072
    v_mfma_f32_16x16x32_bf16 v[220:223], v[116:119], a[10:13], v[236:239]
    buffer_load_dwordx4 v[76:79], v7, s[16:19], s41 offen
    v_mfma_f32_16x16x32_bf16 v[120:123], a[212:215], a[14:17], 0
    v_rcp_f32 v197, v197
    v_rcp_f32 v205, v205
    s_nop 0
    v_rcp_f32 v213, v213
    s_nop 1
    v_rcp_f32 v221, v221
    v_mfma_f32_16x16x32_bf16 v[124:127], a[216:219], a[14:17], v[236:239]
    v_mul_f32 v192, v192, v197
    v_mul_f32 v193, v193, v197
    v_mul_f32 v194, v194, v197
    buffer_load_dwordx4 a[58:61], v1, s[16:19], s42 offen offset:0
    v_mul_f32 v195, v195, v197
    v_mfma_f32_16x16x32_bf16 v[128:131], a[220:223], a[18:21], 0
    v_mul_f32 v196, v196, v197
    v_mul_f32 v200, v200, v205
    v_mul_f32 v201, v201, v205
    v_mul_f32 v202, v202, v205
    v_mul_f32 v203, v203, v205
    v_mfma_f32_16x16x32_bf16 v[132:135], a[224:227], a[18:21], v[236:239]
    v_mul_f32 v204, v204, v205
    buffer_load_dwordx4 a[64:67], v1, s[16:19], s42 offen offset:1024
    v_mul_f32 v208, v208, v213
    v_mul_f32 v209, v209, v213
    v_mul_f32 v210, v210, v213
    v_mfma_f32_16x16x32_bf16 v[136:139], a[228:231], a[20:23], 0
    v_mul_f32 v211, v211, v213
    v_mul_f32 v212, v212, v213
    v_mul_f32 v216, v216, v221
    v_mul_f32 v217, v217, v221
    buffer_load_dwordx4 a[72:75], v1, s[16:19], s42 offen offset:2048
    v_mfma_f32_16x16x32_bf16 v[140:143], a[232:235], a[20:23], v[236:239]
    v_mul_f32 v218, v218, v221
    v_mul_f32 v219, v219, v221
    v_mul_f32 v220, v220, v221
    v_cvt_pk_bf16_f32 v152, v192, v193
    v_cvt_pk_bf16_f32 v153, v194, v195
    v_mfma_f32_16x16x32_bf16 v[144:147], a[236:239], a[24:27], 0
    v_cvt_pk_bf16_f32 v154, v200, v201
    v_cvt_pk_bf16_f32 v155, v202, v203
    buffer_load_dwordx4 a[78:81], v1, s[16:19], s42 offen offset:3072
    v_cvt_pk_bf16_f32 v168, v196, v204
    v_cvt_pk_bf16_f32 v156, v208, v209
    v_mfma_f32_16x16x32_bf16 v[148:151], a[240:243], a[24:27], v[236:239]
    v_cvt_pk_bf16_f32 v157, v210, v211
    v_cvt_pk_bf16_f32 v158, v216, v217
    v_cvt_pk_bf16_f32 v159, v218, v219
    v_cvt_pk_bf16_f32 v169, v212, v220
    buffer_load_dwordx4 v[80:83], v7, s[16:19], s42 offen
    s_waitcnt vmcnt(5)
    v_accvgpr_write_b32 a28, v76
    v_accvgpr_write_b32 a29, v77
    v_accvgpr_write_b32 a34, v76
    v_accvgpr_write_b32 a35, v77
    v_accvgpr_write_b32 a40, v76
    v_accvgpr_write_b32 a41, v77
    v_accvgpr_write_b32 a42, v78
    v_accvgpr_write_b32 a43, v79
    v_accvgpr_write_b32 a48, v78
    v_accvgpr_write_b32 a49, v79
    v_accvgpr_write_b32 a54, v78
    v_accvgpr_write_b32 a55, v79
    v_mfma_f32_16x16x32_bf16 v[192:195], v[88:91], a[28:31], 0
    v_rcp_f32 v125, v125
    v_rcp_f32 v133, v133
    v_rcp_f32 v141, v141
    v_rcp_f32 v149, v149
    v_mfma_f32_16x16x32_bf16 v[196:199], v[92:95], a[28:31], v[236:239]
    v_mul_f32 v120, v120, v125
    v_mul_f32 v121, v121, v125
    v_mul_f32 v122, v122, v125
    buffer_load_dwordx4 a[86:89], v1, s[16:19], s43 offen offset:0
    v_mul_f32 v123, v123, v125
    v_mfma_f32_16x16x32_bf16 v[200:203], v[96:99], a[32:35], 0
    v_mul_f32 v124, v124, v125
    v_mul_f32 v128, v128, v133
    v_mul_f32 v129, v129, v133
    v_mul_f32 v130, v130, v133
    v_mul_f32 v131, v131, v133
    v_mfma_f32_16x16x32_bf16 v[204:207], v[100:103], a[32:35], v[236:239]
    v_mul_f32 v132, v132, v133
    buffer_load_dwordx4 a[92:95], v1, s[16:19], s43 offen offset:1024
    v_mul_f32 v136, v136, v141
    v_mul_f32 v137, v137, v141
    v_mul_f32 v138, v138, v141
    v_mfma_f32_16x16x32_bf16 v[208:211], v[104:107], a[34:37], 0
    v_mul_f32 v139, v139, v141
    v_mul_f32 v140, v140, v141
    v_mul_f32 v144, v144, v149
    v_mul_f32 v145, v145, v149
    buffer_load_dwordx4 a[100:103], v1, s[16:19], s43 offen offset:2048
    v_mfma_f32_16x16x32_bf16 v[212:215], v[108:111], a[34:37], v[236:239]
    v_mul_f32 v146, v146, v149
    v_mul_f32 v147, v147, v149
    v_mul_f32 v148, v148, v149
    v_cvt_pk_bf16_f32 v160, v120, v121
    v_cvt_pk_bf16_f32 v161, v122, v123
    v_mfma_f32_16x16x32_bf16 v[216:219], v[112:115], a[38:41], 0
    v_cvt_pk_bf16_f32 v162, v128, v129
    v_cvt_pk_bf16_f32 v163, v130, v131
    buffer_load_dwordx4 a[106:109], v1, s[16:19], s43 offen offset:3072
    v_cvt_pk_bf16_f32 v170, v124, v132
    v_cvt_pk_bf16_f32 v164, v136, v137
    v_mfma_f32_16x16x32_bf16 v[220:223], v[116:119], a[38:41], v[236:239]
    v_cvt_pk_bf16_f32 v165, v138, v139
    v_cvt_pk_bf16_f32 v166, v144, v145
    v_cvt_pk_bf16_f32 v167, v146, v147
    v_cvt_pk_bf16_f32 v171, v140, v148
    buffer_load_dwordx4 v[84:87], v7, s[16:19], s43 offen
    v_mfma_f32_16x16x32_bf16 v[120:123], a[212:215], a[42:45], 0
    v_rcp_f32 v197, v197
    v_mfma_f32_16x16x32_bf16 v[124:127], a[216:219], a[42:45], v[236:239]
    v_rcp_f32 v205, v205
    v_rcp_f32 v213, v213
    v_mfma_f32_16x16x32_bf16 v[128:131], a[220:223], a[46:49], 0
    v_rcp_f32 v221, v221
    v_mul_f32 v192, v192, v197
    v_mfma_f32_16x16x32_bf16 v[132:135], a[224:227], a[46:49], v[236:239]
    v_mul_f32 v193, v193, v197
    v_mul_f32 v194, v194, v197
    v_mfma_f32_16x16x32_bf16 v[136:139], a[228:231], a[48:51], 0
    buffer_load_dwordx2 v[240:241], v2, s[76:79], s73 offen offset:0
    v_mul_f32 v195, v195, v197
    v_mfma_f32_16x16x32_bf16 v[140:143], a[232:235], a[48:51], v[236:239]
    v_mul_f32 v196, v196, v197
    v_mul_f32 v200, v200, v205
    v_mfma_f32_16x16x32_bf16 v[144:147], a[236:239], a[52:55], 0
    v_mul_f32 v201, v201, v205
    v_mul_f32 v202, v202, v205
    v_mfma_f32_16x16x32_bf16 v[148:151], a[240:243], a[52:55], v[236:239]
    v_mul_f32 v203, v203, v205
    v_mul_f32 v204, v204, v205
    v_mfma_f32_16x16x32_bf16 v[8:11], a[112:115], v[152:155], 0
    buffer_load_dwordx2 v[242:243], v2, s[76:79], s73 offen offset:32
    v_mul_f32 v208, v208, v213
    v_mfma_f32_16x16x32_bf16 v[12:15], a[132:135], v[152:155], 0
    v_mul_f32 v209, v209, v213
    v_mul_f32 v210, v210, v213
    v_mfma_f32_16x16x32_bf16 v[16:19], a[152:155], v[152:155], 0
    v_mul_f32 v211, v211, v213
    v_mul_f32 v212, v212, v213
    v_mfma_f32_16x16x32_bf16 v[20:23], a[172:175], v[152:155], 0
    v_mul_f32 v216, v216, v221
    v_mul_f32 v217, v217, v221
    v_mfma_f32_16x16x32_bf16 v[24:27], a[192:195], v[152:155], 0
    buffer_load_dwordx2 v[244:245], v2, s[76:79], s73 offen offset:64
    v_mul_f32 v218, v218, v221
    v_mfma_f32_16x16x32_bf16 v[8:11], a[116:119], v[156:159], v[8:11]
    v_mul_f32 v219, v219, v221
    v_mul_f32 v220, v220, v221
    v_mfma_f32_16x16x32_bf16 v[12:15], a[136:139], v[156:159], v[12:15]
    v_cvt_pk_bf16_f32 v172, v192, v193
    v_cvt_pk_bf16_f32 v173, v194, v195
    v_mfma_f32_16x16x32_bf16 v[16:19], a[156:159], v[156:159], v[16:19]
    v_cvt_pk_bf16_f32 v174, v200, v201
    v_cvt_pk_bf16_f32 v175, v202, v203
    v_mfma_f32_16x16x32_bf16 v[20:23], a[176:179], v[156:159], v[20:23]
    buffer_load_dwordx2 v[246:247], v2, s[76:79], s73 offen offset:96
    v_cvt_pk_bf16_f32 v188, v196, v204
    v_mfma_f32_16x16x32_bf16 v[24:27], a[196:199], v[156:159], v[24:27]
    v_cvt_pk_bf16_f32 v176, v208, v209
    v_cvt_pk_bf16_f32 v177, v210, v211
    v_mfma_f32_16x16x32_bf16 v[8:11], a[120:123], v[160:163], v[8:11]
    v_cvt_pk_bf16_f32 v178, v216, v217
    v_cvt_pk_bf16_f32 v179, v218, v219
    v_mfma_f32_16x16x32_bf16 v[12:15], a[140:143], v[160:163], v[12:15]
    v_cvt_pk_bf16_f32 v189, v212, v220
    buffer_load_dwordx2 v[248:249], v2, s[76:79], s73 offen offset:128
    s_waitcnt vmcnt(10)
    v_accvgpr_write_b32 a56, v80
    v_accvgpr_write_b32 a57, v81
    v_accvgpr_write_b32 a62, v80
    v_accvgpr_write_b32 a63, v81
    v_accvgpr_write_b32 a68, v80
    v_accvgpr_write_b32 a69, v81
    v_accvgpr_write_b32 a70, v82
    v_accvgpr_write_b32 a71, v83
    v_accvgpr_write_b32 a76, v82
    v_accvgpr_write_b32 a77, v83
    v_accvgpr_write_b32 a82, v82
    v_accvgpr_write_b32 a83, v83
    v_mfma_f32_16x16x32_bf16 v[192:195], v[88:91], a[56:59], 0
    v_rcp_f32 v125, v125
    v_mfma_f32_16x16x32_bf16 v[196:199], v[92:95], a[56:59], v[236:239]
    v_rcp_f32 v133, v133
    v_rcp_f32 v141, v141
    v_mfma_f32_16x16x32_bf16 v[200:203], v[96:99], a[60:63], 0
    v_rcp_f32 v149, v149
    v_mfma_f32_16x16x32_bf16 v[204:207], v[100:103], a[60:63], v[236:239]
    v_mul_f32 v120, v120, v125
    v_mul_f32 v121, v121, v125
    v_mfma_f32_16x16x32_bf16 v[208:211], v[104:107], a[62:65], 0
    v_mul_f32 v122, v122, v125
    v_mul_f32 v123, v123, v125
    v_mfma_f32_16x16x32_bf16 v[212:215], v[108:111], a[62:65], v[236:239]
    v_mul_f32 v124, v124, v125
    v_mfma_f32_16x16x32_bf16 v[216:219], v[112:115], a[66:69], 0
    v_mul_f32 v128, v128, v133
    v_mul_f32 v129, v129, v133
    v_mfma_f32_16x16x32_bf16 v[220:223], v[116:119], a[66:69], v[236:239]
    v_mul_f32 v130, v130, v133
    v_mfma_f32_16x16x32_bf16 v[16:19], a[160:163], v[160:163], v[16:19]
    v_mul_f32 v131, v131, v133
    v_mul_f32 v132, v132, v133
    v_mfma_f32_16x16x32_bf16 v[20:23], a[180:183], v[160:163], v[20:23]
    v_mul_f32 v136, v136, v141
    v_mul_f32 v137, v137, v141
    v_mfma_f32_16x16x32_bf16 v[24:27], a[200:203], v[160:163], v[24:27]
    v_mul_f32 v138, v138, v141
    v_mfma_f32_16x16x32_bf16 v[8:11], a[124:127], v[164:167], v[8:11]
    v_mul_f32 v139, v139, v141
    v_mul_f32 v140, v140, v141
    v_mfma_f32_16x16x32_bf16 v[12:15], a[144:147], v[164:167], v[12:15]
    v_mul_f32 v144, v144, v149
    v_mul_f32 v145, v145, v149
    v_mfma_f32_16x16x32_bf16 v[16:19], a[164:167], v[164:167], v[16:19]
    v_mul_f32 v146, v146, v149
    v_mfma_f32_16x16x32_bf16 v[20:23], a[184:187], v[164:167], v[20:23]
    v_mul_f32 v147, v147, v149
    v_mul_f32 v148, v148, v149
    v_mfma_f32_16x16x32_bf16 v[24:27], a[204:207], v[164:167], v[24:27]
    v_cvt_pk_bf16_f32 v180, v120, v121
    v_mfma_f32_16x16x32_bf16 v[8:11], a[128:131], v[168:171], v[8:11]
    v_cvt_pk_bf16_f32 v181, v122, v123
    v_cvt_pk_bf16_f32 v182, v128, v129
    v_mfma_f32_16x16x32_bf16 v[12:15], a[148:151], v[168:171], v[12:15]
    v_cvt_pk_bf16_f32 v183, v130, v131
    v_cvt_pk_bf16_f32 v190, v124, v132
    v_mfma_f32_16x16x32_bf16 v[16:19], a[168:171], v[168:171], v[16:19]
    v_cvt_pk_bf16_f32 v184, v136, v137
    v_mfma_f32_16x16x32_bf16 v[20:23], a[188:191], v[168:171], v[20:23]
    v_cvt_pk_bf16_f32 v185, v138, v139
    v_cvt_pk_bf16_f32 v186, v144, v145
    v_mfma_f32_16x16x32_bf16 v[24:27], a[208:211], v[168:171], v[24:27]
    v_cvt_pk_bf16_f32 v187, v146, v147
    v_cvt_pk_bf16_f32 v191, v140, v148
    v_mfma_f32_16x16x32_bf16 v[120:123], a[212:215], a[70:73], 0
    v_rcp_f32 v197, v197
    v_mfma_f32_16x16x32_bf16 v[124:127], a[216:219], a[70:73], v[236:239]
    v_rcp_f32 v205, v205
    v_rcp_f32 v213, v213
    v_mfma_f32_16x16x32_bf16 v[128:131], a[220:223], a[74:77], 0
    v_rcp_f32 v221, v221
    v_mul_f32 v192, v192, v197
    v_mfma_f32_16x16x32_bf16 v[132:135], a[224:227], a[74:77], v[236:239]
    v_mul_f32 v193, v193, v197
    v_mfma_f32_16x16x32_bf16 v[136:139], a[228:231], a[76:79], 0
    v_mul_f32 v194, v194, v197
    v_mul_f32 v195, v195, v197
    v_mfma_f32_16x16x32_bf16 v[140:143], a[232:235], a[76:79], v[236:239]
    v_mul_f32 v196, v196, v197
    v_mul_f32 v200, v200, v205
    v_mfma_f32_16x16x32_bf16 v[144:147], a[236:239], a[80:83], 0
    v_mul_f32 v201, v201, v205
    v_mfma_f32_16x16x32_bf16 v[148:151], a[240:243], a[80:83], v[236:239]
    v_mul_f32 v202, v202, v205
    v_mul_f32 v203, v203, v205
    v_mfma_f32_16x16x32_bf16 v[28:31], a[112:115], v[172:175], 0
    v_mul_f32 v204, v204, v205
    v_mul_f32 v208, v208, v213
    v_mfma_f32_16x16x32_bf16 v[32:35], a[132:135], v[172:175], 0
    v_mul_f32 v209, v209, v213
    v_mul_f32 v210, v210, v213
    v_mfma_f32_16x16x32_bf16 v[36:39], a[152:155], v[172:175], 0
    v_mul_f32 v211, v211, v213
    v_mfma_f32_16x16x32_bf16 v[40:43], a[172:175], v[172:175], 0
    v_mul_f32 v212, v212, v213
    v_mul_f32 v216, v216, v221
    v_mfma_f32_16x16x32_bf16 v[44:47], a[192:195], v[172:175], 0
    v_mul_f32 v217, v217, v221
    v_mul_f32 v218, v218, v221
    v_mfma_f32_16x16x32_bf16 v[28:31], a[116:119], v[176:179], v[28:31]
    v_mul_f32 v219, v219, v221
    v_mfma_f32_16x16x32_bf16 v[32:35], a[136:139], v[176:179], v[32:35]
    v_mul_f32 v220, v220, v221
    v_cvt_pk_bf16_f32 v152, v192, v193
    v_mfma_f32_16x16x32_bf16 v[36:39], a[156:159], v[176:179], v[36:39]
    v_cvt_pk_bf16_f32 v153, v194, v195
    v_cvt_pk_bf16_f32 v154, v200, v201
    v_mfma_f32_16x16x32_bf16 v[40:43], a[176:179], v[176:179], v[40:43]
    v_cvt_pk_bf16_f32 v155, v202, v203
    v_mfma_f32_16x16x32_bf16 v[44:47], a[196:199], v[176:179], v[44:47]
    v_cvt_pk_bf16_f32 v168, v196, v204
    v_cvt_pk_bf16_f32 v156, v208, v209
    v_mfma_f32_16x16x32_bf16 v[28:31], a[120:123], v[180:183], v[28:31]
    v_cvt_pk_bf16_f32 v157, v210, v211
    v_cvt_pk_bf16_f32 v158, v216, v217
    v_mfma_f32_16x16x32_bf16 v[32:35], a[140:143], v[180:183], v[32:35]
    v_cvt_pk_bf16_f32 v159, v218, v219
    v_cvt_pk_bf16_f32 v169, v212, v220
    s_waitcnt vmcnt(5)
    v_accvgpr_write_b32 a84, v84
    v_accvgpr_write_b32 a85, v85
    v_accvgpr_write_b32 a90, v84
    v_accvgpr_write_b32 a91, v85
    v_accvgpr_write_b32 a96, v84
    v_accvgpr_write_b32 a97, v85
    v_accvgpr_write_b32 a98, v86
    v_accvgpr_write_b32 a99, v87
    v_accvgpr_write_b32 a104, v86
    v_accvgpr_write_b32 a105, v87
    v_accvgpr_write_b32 a110, v86
    v_accvgpr_write_b32 a111, v87
    v_mfma_f32_16x16x32_bf16 v[192:195], v[88:91], a[84:87], 0
    v_rcp_f32 v125, v125
    v_mfma_f32_16x16x32_bf16 v[196:199], v[92:95], a[84:87], v[236:239]
    v_rcp_f32 v133, v133
    v_rcp_f32 v141, v141
    v_mfma_f32_16x16x32_bf16 v[200:203], v[96:99], a[88:91], 0
    v_rcp_f32 v149, v149
    v_mfma_f32_16x16x32_bf16 v[204:207], v[100:103], a[88:91], v[236:239]
    v_mul_f32 v120, v120, v125
    v_mul_f32 v121, v121, v125
    v_mfma_f32_16x16x32_bf16 v[208:211], v[104:107], a[90:93], 0
    v_mul_f32 v122, v122, v125
    v_mul_f32 v123, v123, v125
    v_mfma_f32_16x16x32_bf16 v[212:215], v[108:111], a[90:93], v[236:239]
    v_mul_f32 v124, v124, v125
    v_mfma_f32_16x16x32_bf16 v[216:219], v[112:115], a[94:97], 0
    v_mul_f32 v128, v128, v133
    v_mul_f32 v129, v129, v133
    v_mfma_f32_16x16x32_bf16 v[220:223], v[116:119], a[94:97], v[236:239]
    v_mul_f32 v130, v130, v133
    v_mfma_f32_16x16x32_bf16 v[36:39], a[160:163], v[180:183], v[36:39]
    v_mul_f32 v131, v131, v133
    v_mul_f32 v132, v132, v133
    v_mfma_f32_16x16x32_bf16 v[40:43], a[180:183], v[180:183], v[40:43]
    v_mul_f32 v136, v136, v141
    v_mul_f32 v137, v137, v141
    v_mfma_f32_16x16x32_bf16 v[44:47], a[200:203], v[180:183], v[44:47]
    v_mul_f32 v138, v138, v141
    v_mfma_f32_16x16x32_bf16 v[28:31], a[124:127], v[184:187], v[28:31]
    v_mul_f32 v139, v139, v141
    v_mul_f32 v140, v140, v141
    v_mfma_f32_16x16x32_bf16 v[32:35], a[144:147], v[184:187], v[32:35]
    v_mul_f32 v144, v144, v149
    v_mul_f32 v145, v145, v149
    v_mfma_f32_16x16x32_bf16 v[36:39], a[164:167], v[184:187], v[36:39]
    v_mul_f32 v146, v146, v149
    v_mfma_f32_16x16x32_bf16 v[40:43], a[184:187], v[184:187], v[40:43]
    v_mul_f32 v147, v147, v149
    v_mul_f32 v148, v148, v149
    v_mfma_f32_16x16x32_bf16 v[44:47], a[204:207], v[184:187], v[44:47]
    v_cvt_pk_bf16_f32 v160, v120, v121
    v_mfma_f32_16x16x32_bf16 v[28:31], a[128:131], v[188:191], v[28:31]
    v_cvt_pk_bf16_f32 v161, v122, v123
    v_cvt_pk_bf16_f32 v162, v128, v129
    v_mfma_f32_16x16x32_bf16 v[32:35], a[148:151], v[188:191], v[32:35]
    v_cvt_pk_bf16_f32 v163, v130, v131
    v_cvt_pk_bf16_f32 v170, v124, v132
    v_mfma_f32_16x16x32_bf16 v[36:39], a[168:171], v[188:191], v[36:39]
    v_cvt_pk_bf16_f32 v164, v136, v137
    v_mfma_f32_16x16x32_bf16 v[40:43], a[188:191], v[188:191], v[40:43]
    v_cvt_pk_bf16_f32 v165, v138, v139
    v_cvt_pk_bf16_f32 v166, v144, v145
    v_mfma_f32_16x16x32_bf16 v[44:47], a[208:211], v[188:191], v[44:47]
    v_cvt_pk_bf16_f32 v167, v146, v147
    v_cvt_pk_bf16_f32 v171, v140, v148
    v_mfma_f32_16x16x32_bf16 v[120:123], a[212:215], a[98:101], 0
    v_rcp_f32 v197, v197
    v_mfma_f32_16x16x32_bf16 v[124:127], a[216:219], a[98:101], v[236:239]
    v_rcp_f32 v205, v205
    v_rcp_f32 v213, v213
    v_mfma_f32_16x16x32_bf16 v[128:131], a[220:223], a[102:105], 0
    v_rcp_f32 v221, v221
    v_mul_f32 v192, v192, v197
    v_mfma_f32_16x16x32_bf16 v[132:135], a[224:227], a[102:105], v[236:239]
    v_mul_f32 v193, v193, v197
    v_mfma_f32_16x16x32_bf16 v[136:139], a[228:231], a[104:107], 0
    v_mul_f32 v194, v194, v197
    v_mul_f32 v195, v195, v197
    v_mfma_f32_16x16x32_bf16 v[140:143], a[232:235], a[104:107], v[236:239]
    v_mul_f32 v196, v196, v197
    v_mul_f32 v200, v200, v205
    v_mfma_f32_16x16x32_bf16 v[144:147], a[236:239], a[108:111], 0
    v_mul_f32 v201, v201, v205
    v_mfma_f32_16x16x32_bf16 v[148:151], a[240:243], a[108:111], v[236:239]
    v_mul_f32 v202, v202, v205
    v_mul_f32 v203, v203, v205
    v_mfma_f32_16x16x32_bf16 v[48:51], a[112:115], v[152:155], 0
    v_mul_f32 v204, v204, v205
    v_mul_f32 v208, v208, v213
    v_mfma_f32_16x16x32_bf16 v[52:55], a[132:135], v[152:155], 0
    v_mul_f32 v209, v209, v213
    v_mul_f32 v210, v210, v213
    v_mfma_f32_16x16x32_bf16 v[56:59], a[152:155], v[152:155], 0
    v_mul_f32 v211, v211, v213
    v_mfma_f32_16x16x32_bf16 v[60:63], a[172:175], v[152:155], 0
    v_mul_f32 v212, v212, v213
    v_mul_f32 v216, v216, v221
    v_mfma_f32_16x16x32_bf16 v[64:67], a[192:195], v[152:155], 0
    v_mul_f32 v217, v217, v221
    v_mul_f32 v218, v218, v221
    v_mfma_f32_16x16x32_bf16 v[48:51], a[116:119], v[156:159], v[48:51]
    v_mul_f32 v219, v219, v221
    v_mfma_f32_16x16x32_bf16 v[52:55], a[136:139], v[156:159], v[52:55]
    v_mul_f32 v220, v220, v221
    v_cvt_pk_bf16_f32 v172, v192, v193
    v_mfma_f32_16x16x32_bf16 v[56:59], a[156:159], v[156:159], v[56:59]
    v_cvt_pk_bf16_f32 v173, v194, v195
    v_cvt_pk_bf16_f32 v174, v200, v201
    v_mfma_f32_16x16x32_bf16 v[60:63], a[176:179], v[156:159], v[60:63]
    v_cvt_pk_bf16_f32 v175, v202, v203
    v_mfma_f32_16x16x32_bf16 v[64:67], a[196:199], v[156:159], v[64:67]
    v_cvt_pk_bf16_f32 v188, v196, v204
    v_cvt_pk_bf16_f32 v176, v208, v209
    v_mfma_f32_16x16x32_bf16 v[48:51], a[120:123], v[160:163], v[48:51]
    v_cvt_pk_bf16_f32 v177, v210, v211
    v_cvt_pk_bf16_f32 v178, v216, v217
    v_mfma_f32_16x16x32_bf16 v[52:55], a[140:143], v[160:163], v[52:55]
    v_cvt_pk_bf16_f32 v179, v218, v219
    v_cvt_pk_bf16_f32 v189, v212, v220
    v_mfma_f32_16x16x32_bf16 v[56:59], a[160:163], v[160:163], v[56:59]
    v_rcp_f32 v125, v125
    v_rcp_f32 v133, v133
    v_mfma_f32_16x16x32_bf16 v[60:63], a[180:183], v[160:163], v[60:63]
    v_rcp_f32 v141, v141
    v_rcp_f32 v149, v149
    v_mul_f32 v120, v120, v125
    v_mfma_f32_16x16x32_bf16 v[64:67], a[200:203], v[160:163], v[64:67]
    v_mul_f32 v121, v121, v125
    v_mul_f32 v122, v122, v125
    v_mfma_f32_16x16x32_bf16 v[48:51], a[124:127], v[164:167], v[48:51]
    v_mul_f32 v123, v123, v125
    v_mul_f32 v124, v124, v125
    v_mul_f32 v128, v128, v133
    v_mfma_f32_16x16x32_bf16 v[52:55], a[144:147], v[164:167], v[52:55]
    v_mul_f32 v129, v129, v133
    v_mul_f32 v130, v130, v133
    v_mul_f32 v131, v131, v133
    v_mfma_f32_16x16x32_bf16 v[56:59], a[164:167], v[164:167], v[56:59]
    v_mul_f32 v132, v132, v133
    v_mul_f32 v136, v136, v141
    v_mfma_f32_16x16x32_bf16 v[60:63], a[184:187], v[164:167], v[60:63]
    v_mul_f32 v137, v137, v141
    v_mul_f32 v138, v138, v141
    v_mul_f32 v139, v139, v141
    v_mfma_f32_16x16x32_bf16 v[64:67], a[204:207], v[164:167], v[64:67]
    v_mul_f32 v140, v140, v141
    v_mul_f32 v144, v144, v149
    v_mfma_f32_16x16x32_bf16 v[48:51], a[128:131], v[168:171], v[48:51]
    v_mul_f32 v145, v145, v149
    v_mul_f32 v146, v146, v149
    v_mul_f32 v147, v147, v149
    v_mfma_f32_16x16x32_bf16 v[52:55], a[148:151], v[168:171], v[52:55]
    v_mul_f32 v148, v148, v149
    v_cvt_pk_bf16_f32 v180, v120, v121
    v_cvt_pk_bf16_f32 v181, v122, v123
    v_mfma_f32_16x16x32_bf16 v[56:59], a[168:171], v[168:171], v[56:59]
    v_cvt_pk_bf16_f32 v182, v128, v129
    v_cvt_pk_bf16_f32 v183, v130, v131
    v_mfma_f32_16x16x32_bf16 v[60:63], a[188:191], v[168:171], v[60:63]
    v_cvt_pk_bf16_f32 v190, v124, v132
    v_cvt_pk_bf16_f32 v184, v136, v137
    v_cvt_pk_bf16_f32 v185, v138, v139
    v_mfma_f32_16x16x32_bf16 v[64:67], a[208:211], v[168:171], v[64:67]
    v_cvt_pk_bf16_f32 v186, v144, v145
    v_cvt_pk_bf16_f32 v187, v146, v147
    v_cvt_pk_bf16_f32 v191, v140, v148
    v_mfma_f32_16x16x32_bf16 v[68:71], a[112:115], v[172:175], 0
    s_add_u32 m0, s80, 0
    v_mfma_f32_16x16x32_bf16 v[72:75], a[132:135], v[172:175], 0
    s_add_u32 s66, s72, 0
    v_mfma_f32_16x16x32_bf16 v[76:79], a[152:155], v[172:175], 0
    buffer_load_dwordx4 v1, s[56:59], s66 offen lds
    v_mfma_f32_16x16x32_bf16 v[80:83], a[172:175], v[172:175], 0
    s_add_u32 m0, s80, 1024
    v_mfma_f32_16x16x32_bf16 v[84:87], a[192:195], v[172:175], 0
    s_add_u32 s66, s72, 20480
    v_mfma_f32_16x16x32_bf16 v[68:71], a[116:119], v[176:179], v[68:71]
    buffer_load_dwordx4 v1, s[56:59], s66 offen lds
    v_mfma_f32_16x16x32_bf16 v[72:75], a[136:139], v[176:179], v[72:75]
    s_add_u32 m0, s80, 2048
    v_mfma_f32_16x16x32_bf16 v[76:79], a[156:159], v[176:179], v[76:79]
    s_add_u32 s66, s72, 40960
    v_mfma_f32_16x16x32_bf16 v[80:83], a[176:179], v[176:179], v[80:83]
    buffer_load_dwordx4 v1, s[56:59], s66 offen lds
    v_mfma_f32_16x16x32_bf16 v[84:87], a[196:199], v[176:179], v[84:87]
    s_add_u32 m0, s80, 3072
    v_mfma_f32_16x16x32_bf16 v[68:71], a[120:123], v[180:183], v[68:71]
    s_add_u32 s66, s72, 61440
    v_mfma_f32_16x16x32_bf16 v[72:75], a[140:143], v[180:183], v[72:75]
    buffer_load_dwordx4 v1, s[56:59], s66 offen lds
    v_mfma_f32_16x16x32_bf16 v[76:79], a[160:163], v[180:183], v[76:79]
    v_mfma_f32_16x16x32_bf16 v[80:83], a[180:183], v[180:183], v[80:83]
    s_add_u32 m0, s80, 4096
    v_mfma_f32_16x16x32_bf16 v[84:87], a[200:203], v[180:183], v[84:87]
    s_add_u32 s66, s72, 81920
    v_mfma_f32_16x16x32_bf16 v[68:71], a[124:127], v[184:187], v[68:71]
    buffer_load_dwordx4 v1, s[56:59], s66 offen lds
    v_mfma_f32_16x16x32_bf16 v[72:75], a[144:147], v[184:187], v[72:75]
    s_add_u32 m0, s80, 5120
    v_mfma_f32_16x16x32_bf16 v[76:79], a[164:167], v[184:187], v[76:79]
    s_add_u32 s66, s72, 102400
    v_mfma_f32_16x16x32_bf16 v[80:83], a[184:187], v[184:187], v[80:83]
    buffer_load_dwordx4 v1, s[56:59], s66 offen lds
    v_mfma_f32_16x16x32_bf16 v[84:87], a[204:207], v[184:187], v[84:87]
    s_add_u32 m0, s80, 24576
    v_mfma_f32_16x16x32_bf16 v[68:71], a[128:131], v[188:191], v[68:71]
    s_add_u32 s66, s72, 4096
    v_mfma_f32_16x16x32_bf16 v[72:75], a[148:151], v[188:191], v[72:75]
    buffer_load_dwordx4 v1, s[56:59], s66 offen lds
    v_mfma_f32_16x16x32_bf16 v[76:79], a[168:171], v[188:191], v[76:79]
    s_add_u32 m0, s80, 25600
    v_mfma_f32_16x16x32_bf16 v[80:83], a[188:191], v[188:191], v[80:83]
    s_add_u32 s66, s72, 24576
    v_mfma_f32_16x16x32_bf16 v[84:87], a[208:211], v[188:191], v[84:87]
    buffer_load_dwordx4 v1, s[56:59], s66 offen lds
    s_add_u32 s66, s36, 1
    s_and_b32 s66, s66, 3
    s_mul_i32 s66, s66, 15360
    s_add_u32 s66, s66, 98304
    v_add_u32 v193, s66, v1
    s_add_u32 s66, s36, 2
    s_and_b32 s66, s66, 3
    s_mul_i32 s66, s66, 15360
    s_add_u32 s66, s66, 103424
    v_add_u32 v194, s66, v1
    s_add_u32 s66, s36, 3
    s_and_b32 s66, s66, 3
    s_mul_i32 s66, s66, 15360
    s_add_u32 s66, s66, 108544
    v_add_u32 v195, s66, v1
    ds_write_b128 v193, v[28:31] offset:0
    s_add_u32 m0, s80, 26624
    s_add_u32 s66, s72, 45056
    buffer_load_dwordx4 v1, s[56:59], s66 offen lds
    ds_write_b128 v193, v[32:35] offset:1024
    s_add_u32 m0, s80, 27648
    s_add_u32 s66, s72, 65536
    buffer_load_dwordx4 v1, s[56:59], s66 offen lds
    ds_write_b128 v193, v[36:39] offset:2048
    s_add_u32 m0, s80, 28672
    s_add_u32 s66, s72, 86016
    buffer_load_dwordx4 v1, s[56:59], s66 offen lds
    ds_write_b128 v193, v[40:43] offset:3072
    s_add_u32 m0, s80, 29696
    s_add_u32 s66, s72, 106496
    buffer_load_dwordx4 v1, s[56:59], s66 offen lds
    ds_write_b128 v193, v[44:47] offset:4096
    s_add_u32 m0, s80, 49152
    s_add_u32 s66, s72, 8192
    buffer_load_dwordx4 v1, s[56:59], s66 offen lds
    s_add_u32 m0, s80, 50176
    ds_write_b128 v194, v[48:51] offset:0
    s_add_u32 s66, s72, 28672
    buffer_load_dwordx4 v1, s[56:59], s66 offen lds
    s_add_u32 m0, s80, 51200
    ds_write_b128 v194, v[52:55] offset:1024
    s_add_u32 s66, s72, 49152
    buffer_load_dwordx4 v1, s[56:59], s66 offen lds
    s_add_u32 m0, s80, 52224
    ds_write_b128 v194, v[56:59] offset:2048
    s_add_u32 s66, s72, 69632
    buffer_load_dwordx4 v1, s[56:59], s66 offen lds
    s_add_u32 m0, s80, 53248
    ds_write_b128 v194, v[60:63] offset:3072
    s_add_u32 s66, s72, 90112
    buffer_load_dwordx4 v1, s[56:59], s66 offen lds
    s_add_u32 m0, s80, 54272
    ds_write_b128 v194, v[64:67] offset:4096
    s_add_u32 s66, s72, 110592
    buffer_load_dwordx4 v1, s[56:59], s66 offen lds
    s_add_u32 m0, s80, 73728
    s_add_u32 s66, s72, 12288
    ds_write_b128 v195, v[68:71] offset:0
    buffer_load_dwordx4 v1, s[56:59], s66 offen lds
    s_add_u32 m0, s80, 74752
    s_add_u32 s66, s72, 32768
    ds_write_b128 v195, v[72:75] offset:1024
    buffer_load_dwordx4 v1, s[56:59], s66 offen lds
    s_add_u32 m0, s80, 75776
    s_add_u32 s66, s72, 53248
    ds_write_b128 v195, v[76:79] offset:2048
    buffer_load_dwordx4 v1, s[56:59], s66 offen lds
    s_add_u32 m0, s80, 76800
    s_add_u32 s66, s72, 73728
    ds_write_b128 v195, v[80:83] offset:3072
    buffer_load_dwordx4 v1, s[56:59], s66 offen lds
    s_add_u32 m0, s80, 77824
    s_add_u32 s66, s72, 94208
    ds_write_b128 v195, v[84:87] offset:4096
    buffer_load_dwordx4 v1, s[56:59], s66 offen lds
    s_add_u32 m0, s80, 78848
    s_add_u32 s66, s72, 114688
    buffer_load_dwordx4 v1, s[56:59], s66 offen lds
    s_mul_i32 s66, s36, 15360
    s_add_u32 s66, s66, 98304
    v_add_u32 v192, s66, v1
    s_waitcnt vmcnt(24)
    v_lshlrev_b32 v200, 16, v240
    v_and_b32 v201, 0xffff0000, v240
    v_lshlrev_b32 v202, 16, v241
    v_and_b32 v203, 0xffff0000, v241
    v_pk_add_f32 v[8:9], v[8:9], v[200:201]
    v_pk_add_f32 v[10:11], v[10:11], v[202:203]
    v_lshlrev_b32 v200, 16, v242
    v_and_b32 v201, 0xffff0000, v242
    v_lshlrev_b32 v202, 16, v243
    v_and_b32 v203, 0xffff0000, v243
    v_pk_add_f32 v[12:13], v[12:13], v[200:201]
    v_pk_add_f32 v[14:15], v[14:15], v[202:203]
    v_lshlrev_b32 v200, 16, v244
    v_and_b32 v201, 0xffff0000, v244
    v_lshlrev_b32 v202, 16, v245
    v_and_b32 v203, 0xffff0000, v245
    v_pk_add_f32 v[16:17], v[16:17], v[200:201]
    v_pk_add_f32 v[18:19], v[18:19], v[202:203]
    v_lshlrev_b32 v200, 16, v246
    v_and_b32 v201, 0xffff0000, v246
    v_lshlrev_b32 v202, 16, v247
    v_and_b32 v203, 0xffff0000, v247
    v_pk_add_f32 v[20:21], v[20:21], v[200:201]
    v_pk_add_f32 v[22:23], v[22:23], v[202:203]
    v_lshlrev_b32 v200, 16, v248
    v_and_b32 v201, 0xffff0000, v248
    v_lshlrev_b32 v202, 16, v249
    v_and_b32 v203, 0xffff0000, v249
    v_pk_add_f32 v[24:25], v[24:25], v[200:201]
    v_pk_add_f32 v[26:27], v[26:27], v[202:203]
    s_waitcnt lgkmcnt(0)
    s_barrier
    ds_read_b128 v[88:91], v192 offset:0
    ds_read_b128 v[92:95], v192 offset:1024
    ds_read_b128 v[96:99], v192 offset:2048
    ds_read_b128 v[100:103], v192 offset:3072
    ds_read_b128 v[104:107], v192 offset:4096
    ds_read_b128 v[108:111], v192 offset:5120
    ds_read_b128 v[112:115], v192 offset:6144
    ds_read_b128 v[116:119], v192 offset:7168
    ds_read_b128 v[120:123], v192 offset:8192
    ds_read_b128 v[124:127], v192 offset:9216
    ds_read_b128 v[128:131], v192 offset:10240
    ds_read_b128 v[132:135], v192 offset:11264
    ds_read_b128 v[136:139], v192 offset:12288
    ds_read_b128 v[140:143], v192 offset:13312
    ds_read_b128 v[144:147], v192 offset:14336
    s_waitcnt lgkmcnt(10)
    v_pk_add_f32 v[8:9], v[8:9], v[88:89]
    v_pk_add_f32 v[10:11], v[10:11], v[90:91]
    v_pk_add_f32 v[12:13], v[12:13], v[92:93]
    v_pk_add_f32 v[14:15], v[14:15], v[94:95]
    v_pk_add_f32 v[16:17], v[16:17], v[96:97]
    v_pk_add_f32 v[18:19], v[18:19], v[98:99]
    v_pk_add_f32 v[20:21], v[20:21], v[100:101]
    v_pk_add_f32 v[22:23], v[22:23], v[102:103]
    v_pk_add_f32 v[24:25], v[24:25], v[104:105]
    v_pk_add_f32 v[26:27], v[26:27], v[106:107]
    s_waitcnt lgkmcnt(5)
    v_pk_add_f32 v[8:9], v[8:9], v[108:109]
    v_pk_add_f32 v[10:11], v[10:11], v[110:111]
    v_pk_add_f32 v[12:13], v[12:13], v[112:113]
    v_pk_add_f32 v[14:15], v[14:15], v[114:115]
    v_pk_add_f32 v[16:17], v[16:17], v[116:117]
    v_pk_add_f32 v[18:19], v[18:19], v[118:119]
    v_pk_add_f32 v[20:21], v[20:21], v[120:121]
    v_pk_add_f32 v[22:23], v[22:23], v[122:123]
    v_pk_add_f32 v[24:25], v[24:25], v[124:125]
    v_pk_add_f32 v[26:27], v[26:27], v[126:127]
    s_waitcnt lgkmcnt(0)
    v_pk_add_f32 v[8:9], v[8:9], v[128:129]
    v_pk_add_f32 v[10:11], v[10:11], v[130:131]
    v_pk_add_f32 v[12:13], v[12:13], v[132:133]
    v_pk_add_f32 v[14:15], v[14:15], v[134:135]
    v_pk_add_f32 v[16:17], v[16:17], v[136:137]
    v_pk_add_f32 v[18:19], v[18:19], v[138:139]
    v_pk_add_f32 v[20:21], v[20:21], v[140:141]
    v_pk_add_f32 v[22:23], v[22:23], v[142:143]
    v_pk_add_f32 v[24:25], v[24:25], v[144:145]
    v_pk_add_f32 v[26:27], v[26:27], v[146:147]
    v_mov_b32 v204, 0
    v_mov_b32 v205, 0
    v_mov_b32 v206, 0x3f803f80
    v_cvt_pk_bf16_f32 v240, v8, v9
    v_cvt_pk_bf16_f32 v241, v10, v11
    v_cvt_pk_bf16_f32 v242, v12, v13
    v_cvt_pk_bf16_f32 v243, v14, v15
    v_cvt_pk_bf16_f32 v244, v16, v17
    v_cvt_pk_bf16_f32 v245, v18, v19
    v_cvt_pk_bf16_f32 v246, v20, v21
    v_cvt_pk_bf16_f32 v247, v22, v23
    v_cvt_pk_bf16_f32 v248, v24, v25
    v_cvt_pk_bf16_f32 v249, v26, v27
    s_mul_i32 s39, s35, 5
    s_lshr_b32 s39, s39, 1
    s_mul_i32 s66, s51, 20
    s_add_u32 s66, s66, s39
    s_lshl_b32 s66, s66, 10
    s_bitcmp1_b32 s35, 0
    s_cbranch_scc1 K2_HODD
    buffer_store_dwordx4 v[240:243], v1, s[28:31], s66 offen sc1
    buffer_store_dwordx4 v[244:247], v1, s[28:31], s66 offen offset:1024 sc1
    buffer_store_dwordx2 v[248:249], v4, s[28:31], s66 offen offset:2048 sc1
    s_branch K2_HDONE
K2_HODD:
    buffer_store_dwordx2 v[240:241], v4, s[28:31], s66 offen offset:512 sc1
    buffer_store_dwordx4 v[242:245], v1, s[28:31], s66 offen offset:1024 sc1
    buffer_store_dwordx4 v[246:249], v1, s[28:31], s66 offen offset:2048 sc1
K2_HDONE:
    v_dot2c_f32_bf16 v204, v240, v206
    v_dot2c_f32_bf16 v205, v240, v240
    v_dot2c_f32_bf16 v204, v241, v206
    v_dot2c_f32_bf16 v205, v241, v241
    v_dot2c_f32_bf16 v204, v242, v206
    v_dot2c_f32_bf16 v205, v242, v242
    v_dot2c_f32_bf16 v204, v243, v206
    v_dot2c_f32_bf16 v205, v243, v243
    v_dot2c_f32_bf16 v204, v244, v206
    v_dot2c_f32_bf16 v205, v244, v244
    v_dot2c_f32_bf16 v204, v245, v206
    v_dot2c_f32_bf16 v205, v245, v245
    v_dot2c_f32_bf16 v204, v246, v206
    v_dot2c_f32_bf16 v205, v246, v246
    v_dot2c_f32_bf16 v204, v247, v206
    v_dot2c_f32_bf16 v205, v247, v247
    v_dot2c_f32_bf16 v204, v248, v206
    v_dot2c_f32_bf16 v205, v248, v248
    v_dot2c_f32_bf16 v204, v249, v206
    v_dot2c_f32_bf16 v205, v249, v249
    s_nop 1
    v_mov_b32 v207, v204
    s_nop 1
    v_permlane32_swap_b32 v204, v207
    v_add_f32 v204, v204, v207
    v_mov_b32 v207, v204
    s_nop 1
    v_permlane16_swap_b32 v204, v207
    v_add_f32 v204, v204, v207
    v_mov_b32 v208, v205
    s_nop 1
    v_permlane32_swap_b32 v205, v208
    v_add_f32 v205, v205, v208
    v_mov_b32 v208, v205
    s_nop 1
    v_permlane16_swap_b32 v205, v208
    v_add_f32 v205, v205, v208
    v_lshlrev_b32 v206, 3, v224
    s_lshl_b32 s66, s51, 10
    s_lshl_b32 s39, s35, 7
    s_add_u32 s66, s66, s39
    buffer_store_dwordx2 v[204:205], v206, s[52:55], s66 offen sc1
    s_add_u32 s16, s6, 0xdf0000
    s_addc_u32 s17, s7, 0
    s_mov_b32 s18, 0x1e0000
    s_mov_b32 s19, 0x20000
    s_mul_i32 s39, s35, 240
    s_mul_i32 s67, s36, 12
    s_add_u32 s66, s39, s67
    s_lshl_b32 s44, s66, 10
    s_add_u32 s45, s44, 49152
    s_add_u32 s46, s44, 98304
    s_add_u32 s47, s44, 147456
    s_add_u32 s48, s44, 196608
    buffer_load_dwordx4 a[0:3], v1, s[16:19], s44 offen offset:0
    buffer_load_dwordx4 a[4:7], v1, s[16:19], s45 offen offset:0
    buffer_load_dwordx4 a[8:11], v1, s[16:19], s46 offen offset:0
    buffer_load_dwordx4 a[12:15], v1, s[16:19], s47 offen offset:0
    buffer_load_dwordx4 a[16:19], v1, s[16:19], s48 offen offset:0
    s_waitcnt vmcnt(5)
    v_mov_b32 v254, 1
    v_mov_b32 v255, s68
    s_mov_b64 exec, 1
    buffer_atomic_add v254, v255, s[60:63], 0 offen
    s_mov_b64 exec, -1
    s_barrier
    s_add_u32 m0, s80, 98304
    s_add_u32 s66, s72, 16384
    buffer_load_dwordx4 v1, s[56:59], s66 offen lds
    s_add_u32 m0, s80, 99328
    s_add_u32 s66, s72, 36864
    buffer_load_dwordx4 v1, s[56:59], s66 offen lds
    s_add_u32 m0, s80, 100352
    s_add_u32 s66, s72, 57344
    buffer_load_dwordx4 v1, s[56:59], s66 offen lds
    s_add_u32 m0, s80, 101376
    s_add_u32 s66, s72, 77824
    buffer_load_dwordx4 v1, s[56:59], s66 offen lds
    s_add_u32 m0, s80, 102400
    s_add_u32 s66, s72, 98304
    buffer_load_dwordx4 v1, s[56:59], s66 offen lds
    s_add_u32 m0, s80, 103424
    s_add_u32 s66, s72, 118784
    buffer_load_dwordx4 v1, s[56:59], s66 offen lds
    buffer_load_dwordx4 a[20:23], v1, s[16:19], s44 offen offset:1024
    buffer_load_dwordx4 a[24:27], v1, s[16:19], s45 offen offset:1024
    buffer_load_dwordx4 a[28:31], v1, s[16:19], s46 offen offset:1024
    buffer_load_dwordx4 a[32:35], v1, s[16:19], s47 offen offset:1024
    buffer_load_dwordx4 a[36:39], v1, s[16:19], s48 offen offset:1024
    buffer_load_dwordx4 a[40:43], v1, s[16:19], s44 offen offset:2048
    buffer_load_dwordx4 a[44:47], v1, s[16:19], s45 offen offset:2048
    buffer_load_dwordx4 a[48:51], v1, s[16:19], s46 offen offset:2048
    buffer_load_dwordx4 a[52:55], v1, s[16:19], s47 offen offset:2048
    buffer_load_dwordx4 a[56:59], v1, s[16:19], s48 offen offset:2048
    buffer_load_dwordx4 a[60:63], v1, s[16:19], s44 offen offset:3072
    buffer_load_dwordx4 a[64:67], v1, s[16:19], s45 offen offset:3072
    buffer_load_dwordx4 a[68:71], v1, s[16:19], s46 offen offset:3072
    buffer_load_dwordx4 a[72:75], v1, s[16:19], s47 offen offset:3072
    buffer_load_dwordx4 a[76:79], v1, s[16:19], s48 offen offset:3072
    s_lshl_b32 s50, s64, 3
    s_lshl_b32 s66, s36, 1
    s_add_u32 s50, s50, s66
    s_mul_i32 s40, s50, 20480
    s_add_u32 s41, s40, 20480
    s_add_u32 s12, s6, 0x2c0000
    s_addc_u32 s13, s7, 0
    s_mov_b32 s14, 0x280000
    s_mov_b32 s15, 0x20000
    s_add_u32 s20, s6, 0x540000
    s_addc_u32 s21, s7, 0
    s_mov_b32 s22, 0x600000
    s_mov_b32 s23, 0x20000
    s_mov_b32 s28, s10
    s_mov_b32 s29, s11
    s_mov_b32 s30, 0xc00
    s_mov_b32 s31, 0x20000
    s_add_u32 s56, s6, 0xe000
    s_addc_u32 s57, s7, 0
    s_mov_b32 s58, 0x1800
    s_mov_b32 s59, 0x20000
    s_mov_b32 s75, 0
K2_PL_S2:
    s_load_dword s74, s[26:27], s69 glc
    s_waitcnt lgkmcnt(0)
    s_add_u32 s75, s75, 1
    s_cmp_ge_u32 s74, 16
    s_cbranch_scc1 K2_PD_S2
    s_cmp_lt_u32 s75, 2000000
    s_cbranch_scc1 K2_PL_S2
K2_PD_S2:
    buffer_load_dwordx4 v[104:107], v1, s[12:15], s40 offen offset:0 sc1
    buffer_load_dwordx4 v[120:123], v1, s[12:15], s41 offen offset:0 sc1
    buffer_load_dwordx4 v[108:111], v1, s[12:15], s40 offen offset:1024 sc1
    buffer_load_dwordx4 v[124:127], v1, s[12:15], s41 offen offset:1024 sc1
    buffer_load_dwordx2 v[112:113], v4, s[12:15], s40 offen offset:2048 sc1
    buffer_load_dwordx2 v[114:115], v4, s[12:15], s40 offen offset:2560 sc1
    buffer_load_dwordx2 v[128:129], v4, s[12:15], s41 offen offset:2048 sc1
    buffer_load_dwordx2 v[130:131], v4, s[12:15], s41 offen offset:2560 sc1
    buffer_load_dwordx4 v[116:119], v1, s[12:15], s40 offen offset:3072 sc1
    buffer_load_dwordx4 v[132:135], v1, s[12:15], s41 offen offset:3072 sc1
    s_add_u32 s40, s40, 4096
    s_add_u32 s41, s41, 4096
    buffer_load_dwordx4 v[136:139], v1, s[12:15], s40 offen offset:0 sc1
    buffer_load_dwordx4 v[152:155], v1, s[12:15], s41 offen offset:0 sc1
    buffer_load_dwordx4 v[140:143], v1, s[12:15], s40 offen offset:1024 sc1
    buffer_load_dwordx4 v[156:159], v1, s[12:15], s41 offen offset:1024 sc1
    buffer_load_dwordx4 v[144:147], v1, s[12:15], s40 offen offset:2048 sc1
    buffer_load_dwordx4 v[160:163], v1, s[12:15], s41 offen offset:2048 sc1
    buffer_load_dwordx2 v[148:149], v4, s[12:15], s40 offen offset:3072 sc1
    buffer_load_dwordx2 v[150:151], v4, s[12:15], s40 offen offset:3584 sc1
    buffer_load_dwordx2 v[164:165], v4, s[12:15], s41 offen offset:3072 sc1
    buffer_load_dwordx2 v[166:167], v4, s[12:15], s41 offen offset:3584 sc1
    s_add_u32 s40, s40, 4096
    s_add_u32 s41, s41, 4096
    buffer_load_dwordx4 v[168:171], v1, s[12:15], s40 offen offset:0 sc1
    buffer_load_dwordx4 v[184:187], v1, s[12:15], s41 offen offset:0 sc1
    buffer_load_dwordx4 v[172:175], v1, s[12:15], s40 offen offset:1024 sc1
    buffer_load_dwordx4 v[188:191], v1, s[12:15], s41 offen offset:1024 sc1
    buffer_load_dwordx4 v[176:179], v1, s[12:15], s40 offen offset:2048 sc1
    buffer_load_dwordx4 v[192:195], v1, s[12:15], s41 offen offset:2048 sc1
    buffer_load_dwordx4 v[180:183], v1, s[12:15], s40 offen offset:3072 sc1
    buffer_load_dwordx4 v[196:199], v1, s[12:15], s41 offen offset:3072 sc1
    s_add_u32 s40, s40, 4096
    s_add_u32 s41, s41, 4096
    v_add_u32 v200, 0x10000, v1
    s_waitcnt vmcnt(18)
    s_barrier
    ds_read_b128 v[56:59], v1 offset:0
    ds_read_b128 v[60:63], v1 offset:1024
    ds_read_b128 v[64:67], v1 offset:2048
    ds_read_b128 v[68:71], v1 offset:3072
    ds_read_b128 v[72:75], v1 offset:4096
    ds_read_b128 v[76:79], v1 offset:5120
    s_waitcnt lgkmcnt(0)
    v_mfma_f32_16x16x32_bf16 v[8:11], v[56:59], v[104:107], 0
    ds_read_b128 v[80:83], v1 offset:6144
    v_mfma_f32_16x16x32_bf16 v[32:35], v[56:59], v[120:123], 0
    ds_read_b128 v[84:87], v1 offset:7168
    v_mfma_f32_16x16x32_bf16 v[12:15], v[60:63], v[104:107], 0
    ds_read_b128 v[88:91], v1 offset:8192
    v_mfma_f32_16x16x32_bf16 v[36:39], v[60:63], v[120:123], 0
    ds_read_b128 v[92:95], v1 offset:9216
    v_mfma_f32_16x16x32_bf16 v[16:19], v[64:67], v[104:107], 0
    ds_read_b128 v[96:99], v1 offset:10240
    v_mfma_f32_16x16x32_bf16 v[40:43], v[64:67], v[120:123], 0
    ds_read_b128 v[100:103], v1 offset:11264
    v_mfma_f32_16x16x32_bf16 v[20:23], v[68:71], v[104:107], 0
    v_and_b32 v201, 15, v3
    v_mfma_f32_16x16x32_bf16 v[44:47], v[68:71], v[120:123], 0
    v_lshrrev_b32 v202, 4, v3
    v_mfma_f32_16x16x32_bf16 v[24:27], v[72:75], v[104:107], 0
    v_lshlrev_b32 v203, 3, v201
    v_mfma_f32_16x16x32_bf16 v[48:51], v[72:75], v[120:123], 0
    v_lshl_add_u32 v203, v202, 8, v203
    v_mfma_f32_16x16x32_bf16 v[28:31], v[76:79], v[104:107], 0
    s_lshl_b32 s66, s50, 10
    v_mfma_f32_16x16x32_bf16 v[52:55], v[76:79], v[120:123], 0
    buffer_load_dwordx2 v[204:205], v203, s[52:55], s66 offen offset:0 sc1
    s_waitcnt lgkmcnt(0)
    v_mfma_f32_16x16x32_bf16 v[8:11], v[80:83], v[108:111], v[8:11]
    ds_read_b128 v[56:59], v1 offset:12288
    v_mfma_f32_16x16x32_bf16 v[32:35], v[80:83], v[124:127], v[32:35]
    ds_read_b128 v[60:63], v1 offset:13312
    v_mfma_f32_16x16x32_bf16 v[12:15], v[84:87], v[108:111], v[12:15]
    ds_read_b128 v[64:67], v1 offset:14336
    v_mfma_f32_16x16x32_bf16 v[36:39], v[84:87], v[124:127], v[36:39]
    ds_read_b128 v[68:71], v1 offset:15360
    v_mfma_f32_16x16x32_bf16 v[16:19], v[88:91], v[108:111], v[16:19]
    ds_read_b128 v[72:75], v1 offset:16384
    v_mfma_f32_16x16x32_bf16 v[40:43], v[88:91], v[124:127], v[40:43]
    ds_read_b128 v[76:79], v1 offset:17408
    v_mfma_f32_16x16x32_bf16 v[20:23], v[92:95], v[108:111], v[20:23]
    buffer_load_dwordx2 v[206:207], v203, s[52:55], s66 offen offset:128 sc1
    v_mfma_f32_16x16x32_bf16 v[44:47], v[92:95], v[124:127], v[44:47]
    buffer_load_dwordx2 v[208:209], v203, s[52:55], s66 offen offset:1024 sc1
    v_mfma_f32_16x16x32_bf16 v[24:27], v[96:99], v[108:111], v[24:27]
    buffer_load_dwordx2 v[210:211], v203, s[52:55], s66 offen offset:1152 sc1
    v_mfma_f32_16x16x32_bf16 v[48:51], v[96:99], v[124:127], v[48:51]
    v_lshlrev_b32 v203, 3, v202
    v_mfma_f32_16x16x32_bf16 v[28:31], v[100:103], v[108:111], v[28:31]
    s_mul_i32 s66, s65, 192
    v_mfma_f32_16x16x32_bf16 v[52:55], v[100:103], v[124:127], v[52:55]
    buffer_load_dwordx2 v[212:213], v203, s[28:31], s66 offen offset:0
    buffer_load_dwordx2 v[214:215], v203, s[28:31], s66 offen offset:32
    s_waitcnt lgkmcnt(0)
    v_mfma_f32_16x16x32_bf16 v[8:11], v[56:59], v[112:115], v[8:11]
    ds_read_b128 v[80:83], v1 offset:18432
    v_mfma_f32_16x16x32_bf16 v[32:35], v[56:59], v[128:131], v[32:35]
    ds_read_b128 v[84:87], v1 offset:19456
    v_mfma_f32_16x16x32_bf16 v[12:15], v[60:63], v[112:115], v[12:15]
    ds_read_b128 v[88:91], v1 offset:20480
    v_mfma_f32_16x16x32_bf16 v[36:39], v[60:63], v[128:131], v[36:39]
    ds_read_b128 v[92:95], v1 offset:21504
    v_mfma_f32_16x16x32_bf16 v[16:19], v[64:67], v[112:115], v[16:19]
    ds_read_b128 v[96:99], v1 offset:22528
    v_mfma_f32_16x16x32_bf16 v[40:43], v[64:67], v[128:131], v[40:43]
    ds_read_b128 v[100:103], v1 offset:23552
    v_mfma_f32_16x16x32_bf16 v[20:23], v[68:71], v[112:115], v[20:23]
    buffer_load_dwordx2 v[216:217], v203, s[28:31], s66 offen offset:64
    v_mfma_f32_16x16x32_bf16 v[44:47], v[68:71], v[128:131], v[44:47]
    buffer_load_dwordx2 v[218:219], v203, s[28:31], s66 offen offset:96
    v_mfma_f32_16x16x32_bf16 v[24:27], v[72:75], v[112:115], v[24:27]
    buffer_load_dwordx2 v[220:221], v203, s[28:31], s66 offen offset:128
    v_mfma_f32_16x16x32_bf16 v[48:51], v[72:75], v[128:131], v[48:51]
    buffer_load_dwordx2 v[222:223], v203, s[28:31], s66 offen offset:160
    v_mfma_f32_16x16x32_bf16 v[28:31], v[76:79], v[112:115], v[28:31]
    s_add_u32 s44, s44, 4096
    v_mfma_f32_16x16x32_bf16 v[52:55], v[76:79], v[128:131], v[52:55]
    s_add_u32 s45, s45, 4096
    s_add_u32 s46, s46, 4096
    s_waitcnt lgkmcnt(0)
    v_mfma_f32_16x16x32_bf16 v[8:11], v[80:83], v[116:119], v[8:11]
    ds_read_b128 v[56:59], v1 offset:24576
    v_mfma_f32_16x16x32_bf16 v[32:35], v[80:83], v[132:135], v[32:35]
    ds_read_b128 v[60:63], v1 offset:25600
    v_mfma_f32_16x16x32_bf16 v[12:15], v[84:87], v[116:119], v[12:15]
    ds_read_b128 v[64:67], v1 offset:26624
    v_mfma_f32_16x16x32_bf16 v[36:39], v[84:87], v[132:135], v[36:39]
    ds_read_b128 v[68:71], v1 offset:27648
    v_mfma_f32_16x16x32_bf16 v[16:19], v[88:91], v[116:119], v[16:19]
    ds_read_b128 v[72:75], v1 offset:28672
    v_mfma_f32_16x16x32_bf16 v[40:43], v[88:91], v[132:135], v[40:43]
    ds_read_b128 v[76:79], v1 offset:29696
    v_mfma_f32_16x16x32_bf16 v[20:23], v[92:95], v[116:119], v[20:23]
    s_add_u32 s47, s47, 4096
    v_mfma_f32_16x16x32_bf16 v[44:47], v[92:95], v[132:135], v[44:47]
    s_add_u32 s48, s48, 4096
    v_mfma_f32_16x16x32_bf16 v[24:27], v[96:99], v[116:119], v[24:27]
    buffer_load_dwordx4 a[80:83], v1, s[16:19], s44 offen offset:0
    v_mfma_f32_16x16x32_bf16 v[48:51], v[96:99], v[132:135], v[48:51]
    buffer_load_dwordx4 a[84:87], v1, s[16:19], s45 offen offset:0
    v_mfma_f32_16x16x32_bf16 v[28:31], v[100:103], v[116:119], v[28:31]
    buffer_load_dwordx4 a[88:91], v1, s[16:19], s46 offen offset:0
    v_mfma_f32_16x16x32_bf16 v[52:55], v[100:103], v[132:135], v[52:55]
    buffer_load_dwordx4 a[92:95], v1, s[16:19], s47 offen offset:0
    buffer_load_dwordx4 a[96:99], v1, s[16:19], s48 offen offset:0
    s_waitcnt vmcnt(23)
    s_waitcnt lgkmcnt(0)
    v_mfma_f32_16x16x32_bf16 v[8:11], v[56:59], v[136:139], v[8:11]
    ds_read_b128 v[80:83], v1 offset:30720
    v_mfma_f32_16x16x32_bf16 v[32:35], v[56:59], v[152:155], v[32:35]
    ds_read_b128 v[84:87], v1 offset:31744
    v_mfma_f32_16x16x32_bf16 v[12:15], v[60:63], v[136:139], v[12:15]
    ds_read_b128 v[88:91], v1 offset:32768
    v_mfma_f32_16x16x32_bf16 v[36:39], v[60:63], v[152:155], v[36:39]
    ds_read_b128 v[92:95], v1 offset:33792
    v_mfma_f32_16x16x32_bf16 v[16:19], v[64:67], v[136:139], v[16:19]
    ds_read_b128 v[96:99], v1 offset:34816
    v_mfma_f32_16x16x32_bf16 v[40:43], v[64:67], v[152:155], v[40:43]
    ds_read_b128 v[100:103], v1 offset:35840
    v_mfma_f32_16x16x32_bf16 v[20:23], v[68:71], v[136:139], v[20:23]
    v_mfma_f32_16x16x32_bf16 v[44:47], v[68:71], v[152:155], v[44:47]
    buffer_load_dwordx2 v[104:105], v4, s[12:15], s40 offen offset:0 sc1
    v_mfma_f32_16x16x32_bf16 v[24:27], v[72:75], v[136:139], v[24:27]
    buffer_load_dwordx2 v[106:107], v4, s[12:15], s40 offen offset:512 sc1
    v_mfma_f32_16x16x32_bf16 v[48:51], v[72:75], v[152:155], v[48:51]
    v_mfma_f32_16x16x32_bf16 v[28:31], v[76:79], v[136:139], v[28:31]
    buffer_load_dwordx2 v[120:121], v4, s[12:15], s41 offen offset:0 sc1
    v_mfma_f32_16x16x32_bf16 v[52:55], v[76:79], v[152:155], v[52:55]
    buffer_load_dwordx2 v[122:123], v4, s[12:15], s41 offen offset:512 sc1
    s_waitcnt lgkmcnt(0)
    v_mfma_f32_16x16x32_bf16 v[8:11], v[80:83], v[140:143], v[8:11]
    ds_read_b128 v[56:59], v1 offset:36864
    v_mfma_f32_16x16x32_bf16 v[32:35], v[80:83], v[156:159], v[32:35]
    ds_read_b128 v[60:63], v1 offset:37888
    v_mfma_f32_16x16x32_bf16 v[12:15], v[84:87], v[140:143], v[12:15]
    ds_read_b128 v[64:67], v1 offset:38912
    v_mfma_f32_16x16x32_bf16 v[36:39], v[84:87], v[156:159], v[36:39]
    ds_read_b128 v[68:71], v1 offset:39936
    v_mfma_f32_16x16x32_bf16 v[16:19], v[88:91], v[140:143], v[16:19]
    ds_read_b128 v[72:75], v1 offset:40960
    v_mfma_f32_16x16x32_bf16 v[40:43], v[88:91], v[156:159], v[40:43]
    ds_read_b128 v[76:79], v1 offset:41984
    v_mfma_f32_16x16x32_bf16 v[20:23], v[92:95], v[140:143], v[20:23]
    v_mfma_f32_16x16x32_bf16 v[44:47], v[92:95], v[156:159], v[44:47]
    buffer_load_dwordx4 v[108:111], v1, s[12:15], s40 offen offset:1024 sc1
    v_mfma_f32_16x16x32_bf16 v[24:27], v[96:99], v[140:143], v[24:27]
    buffer_load_dwordx4 v[124:127], v1, s[12:15], s41 offen offset:1024 sc1
    v_mfma_f32_16x16x32_bf16 v[48:51], v[96:99], v[156:159], v[48:51]
    v_mfma_f32_16x16x32_bf16 v[28:31], v[100:103], v[140:143], v[28:31]
    buffer_load_dwordx4 v[112:115], v1, s[12:15], s40 offen offset:2048 sc1
    v_mfma_f32_16x16x32_bf16 v[52:55], v[100:103], v[156:159], v[52:55]
    buffer_load_dwordx4 v[128:131], v1, s[12:15], s41 offen offset:2048 sc1
    s_waitcnt lgkmcnt(0)
    v_mfma_f32_16x16x32_bf16 v[8:11], v[56:59], v[144:147], v[8:11]
    ds_read_b128 v[80:83], v1 offset:43008
    v_mfma_f32_16x16x32_bf16 v[32:35], v[56:59], v[160:163], v[32:35]
    ds_read_b128 v[84:87], v1 offset:44032
    v_mfma_f32_16x16x32_bf16 v[12:15], v[60:63], v[144:147], v[12:15]
    ds_read_b128 v[88:91], v1 offset:45056
    v_mfma_f32_16x16x32_bf16 v[36:39], v[60:63], v[160:163], v[36:39]
    ds_read_b128 v[92:95], v1 offset:46080
    v_mfma_f32_16x16x32_bf16 v[16:19], v[64:67], v[144:147], v[16:19]
    ds_read_b128 v[96:99], v1 offset:47104
    v_mfma_f32_16x16x32_bf16 v[40:43], v[64:67], v[160:163], v[40:43]
    ds_read_b128 v[100:103], v1 offset:48128
    v_mfma_f32_16x16x32_bf16 v[20:23], v[68:71], v[144:147], v[20:23]
    v_mfma_f32_16x16x32_bf16 v[44:47], v[68:71], v[160:163], v[44:47]
    buffer_load_dwordx4 v[116:119], v1, s[12:15], s40 offen offset:3072 sc1
    v_mfma_f32_16x16x32_bf16 v[24:27], v[72:75], v[144:147], v[24:27]
    buffer_load_dwordx4 v[132:135], v1, s[12:15], s41 offen offset:3072 sc1
    v_mfma_f32_16x16x32_bf16 v[48:51], v[72:75], v[160:163], v[48:51]
    v_mfma_f32_16x16x32_bf16 v[28:31], v[76:79], v[144:147], v[28:31]
    s_add_u32 s40, s40, 4096
    v_mfma_f32_16x16x32_bf16 v[52:55], v[76:79], v[160:163], v[52:55]
    s_add_u32 s41, s41, 4096
    s_waitcnt lgkmcnt(0)
    v_mfma_f32_16x16x32_bf16 v[8:11], v[80:83], v[148:151], v[8:11]
    ds_read_b128 v[56:59], v1 offset:49152
    v_mfma_f32_16x16x32_bf16 v[32:35], v[80:83], v[164:167], v[32:35]
    ds_read_b128 v[60:63], v1 offset:50176
    v_mfma_f32_16x16x32_bf16 v[12:15], v[84:87], v[148:151], v[12:15]
    ds_read_b128 v[64:67], v1 offset:51200
    v_mfma_f32_16x16x32_bf16 v[36:39], v[84:87], v[164:167], v[36:39]
    ds_read_b128 v[68:71], v1 offset:52224
    v_mfma_f32_16x16x32_bf16 v[16:19], v[88:91], v[148:151], v[16:19]
    ds_read_b128 v[72:75], v1 offset:53248
    v_mfma_f32_16x16x32_bf16 v[40:43], v[88:91], v[164:167], v[40:43]
    ds_read_b128 v[76:79], v1 offset:54272
    v_mfma_f32_16x16x32_bf16 v[20:23], v[92:95], v[148:151], v[20:23]
    v_mfma_f32_16x16x32_bf16 v[44:47], v[92:95], v[164:167], v[44:47]
    buffer_load_dwordx4 a[100:103], v1, s[16:19], s44 offen offset:1024
    v_mfma_f32_16x16x32_bf16 v[24:27], v[96:99], v[148:151], v[24:27]
    buffer_load_dwordx4 a[104:107], v1, s[16:19], s45 offen offset:1024
    v_mfma_f32_16x16x32_bf16 v[48:51], v[96:99], v[164:167], v[48:51]
    buffer_load_dwordx4 a[108:111], v1, s[16:19], s46 offen offset:1024
    v_mfma_f32_16x16x32_bf16 v[28:31], v[100:103], v[148:151], v[28:31]
    buffer_load_dwordx4 a[112:115], v1, s[16:19], s47 offen offset:1024
    v_mfma_f32_16x16x32_bf16 v[52:55], v[100:103], v[164:167], v[52:55]
    buffer_load_dwordx4 a[116:119], v1, s[16:19], s48 offen offset:1024
    s_waitcnt vmcnt(30)
    s_waitcnt lgkmcnt(0)
    v_mfma_f32_16x16x32_bf16 v[8:11], v[56:59], v[168:171], v[8:11]
    ds_read_b128 v[80:83], v1 offset:55296
    v_mfma_f32_16x16x32_bf16 v[32:35], v[56:59], v[184:187], v[32:35]
    ds_read_b128 v[84:87], v1 offset:56320
    v_mfma_f32_16x16x32_bf16 v[12:15], v[60:63], v[168:171], v[12:15]
    ds_read_b128 v[88:91], v1 offset:57344
    v_mfma_f32_16x16x32_bf16 v[36:39], v[60:63], v[184:187], v[36:39]
    ds_read_b128 v[92:95], v1 offset:58368
    v_mfma_f32_16x16x32_bf16 v[16:19], v[64:67], v[168:171], v[16:19]
    ds_read_b128 v[96:99], v1 offset:59392
    v_mfma_f32_16x16x32_bf16 v[40:43], v[64:67], v[184:187], v[40:43]
    ds_read_b128 v[100:103], v1 offset:60416
    v_mfma_f32_16x16x32_bf16 v[20:23], v[68:71], v[168:171], v[20:23]
    v_mfma_f32_16x16x32_bf16 v[44:47], v[68:71], v[184:187], v[44:47]
    buffer_load_dwordx4 v[136:139], v1, s[12:15], s40 offen offset:0 sc1
    v_mfma_f32_16x16x32_bf16 v[24:27], v[72:75], v[168:171], v[24:27]
    v_mfma_f32_16x16x32_bf16 v[48:51], v[72:75], v[184:187], v[48:51]
    buffer_load_dwordx4 v[152:155], v1, s[12:15], s41 offen offset:0 sc1
    v_mfma_f32_16x16x32_bf16 v[28:31], v[76:79], v[168:171], v[28:31]
    v_mfma_f32_16x16x32_bf16 v[52:55], v[76:79], v[184:187], v[52:55]
    buffer_load_dwordx2 v[140:141], v4, s[12:15], s40 offen offset:1024 sc1
    s_waitcnt lgkmcnt(0)
    v_mfma_f32_16x16x32_bf16 v[8:11], v[80:83], v[172:175], v[8:11]
    ds_read_b128 v[56:59], v1 offset:61440
    v_mfma_f32_16x16x32_bf16 v[32:35], v[80:83], v[188:191], v[32:35]
    ds_read_b128 v[60:63], v1 offset:62464
    v_mfma_f32_16x16x32_bf16 v[12:15], v[84:87], v[172:175], v[12:15]
    ds_read_b128 v[64:67], v1 offset:63488
    v_mfma_f32_16x16x32_bf16 v[36:39], v[84:87], v[188:191], v[36:39]
    ds_read_b128 v[68:71], v1 offset:64512
    v_mfma_f32_16x16x32_bf16 v[16:19], v[88:91], v[172:175], v[16:19]
    ds_read_b128 v[72:75], v200 offset:0
    v_mfma_f32_16x16x32_bf16 v[40:43], v[88:91], v[188:191], v[40:43]
    ds_read_b128 v[76:79], v200 offset:1024
    v_mfma_f32_16x16x32_bf16 v[20:23], v[92:95], v[172:175], v[20:23]
    v_mfma_f32_16x16x32_bf16 v[44:47], v[92:95], v[188:191], v[44:47]
    buffer_load_dwordx2 v[142:143], v4, s[12:15], s40 offen offset:1536 sc1
    v_mfma_f32_16x16x32_bf16 v[24:27], v[96:99], v[172:175], v[24:27]
    v_mfma_f32_16x16x32_bf16 v[48:51], v[96:99], v[188:191], v[48:51]
    buffer_load_dwordx2 v[156:157], v4, s[12:15], s41 offen offset:1024 sc1
    v_mfma_f32_16x16x32_bf16 v[28:31], v[100:103], v[172:175], v[28:31]
    v_mfma_f32_16x16x32_bf16 v[52:55], v[100:103], v[188:191], v[52:55]
    buffer_load_dwordx2 v[158:159], v4, s[12:15], s41 offen offset:1536 sc1
    s_waitcnt lgkmcnt(0)
    v_mfma_f32_16x16x32_bf16 v[8:11], v[56:59], v[176:179], v[8:11]
    ds_read_b128 v[80:83], v200 offset:2048
    v_mfma_f32_16x16x32_bf16 v[32:35], v[56:59], v[192:195], v[32:35]
    ds_read_b128 v[84:87], v200 offset:3072
    v_mfma_f32_16x16x32_bf16 v[12:15], v[60:63], v[176:179], v[12:15]
    ds_read_b128 v[88:91], v200 offset:4096
    v_mfma_f32_16x16x32_bf16 v[36:39], v[60:63], v[192:195], v[36:39]
    ds_read_b128 v[92:95], v200 offset:5120
    v_mfma_f32_16x16x32_bf16 v[16:19], v[64:67], v[176:179], v[16:19]
    ds_read_b128 v[96:99], v200 offset:6144
    v_mfma_f32_16x16x32_bf16 v[40:43], v[64:67], v[192:195], v[40:43]
    ds_read_b128 v[100:103], v200 offset:7168
    v_mfma_f32_16x16x32_bf16 v[20:23], v[68:71], v[176:179], v[20:23]
    v_mfma_f32_16x16x32_bf16 v[44:47], v[68:71], v[192:195], v[44:47]
    buffer_load_dwordx4 v[144:147], v1, s[12:15], s40 offen offset:2048 sc1
    v_mfma_f32_16x16x32_bf16 v[24:27], v[72:75], v[176:179], v[24:27]
    v_mfma_f32_16x16x32_bf16 v[48:51], v[72:75], v[192:195], v[48:51]
    buffer_load_dwordx4 v[160:163], v1, s[12:15], s41 offen offset:2048 sc1
    v_mfma_f32_16x16x32_bf16 v[28:31], v[76:79], v[176:179], v[28:31]
    v_mfma_f32_16x16x32_bf16 v[52:55], v[76:79], v[192:195], v[52:55]
    buffer_load_dwordx4 v[148:151], v1, s[12:15], s40 offen offset:3072 sc1
    s_waitcnt lgkmcnt(0)
    v_mfma_f32_16x16x32_bf16 v[8:11], v[80:83], v[180:183], v[8:11]
    ds_read_b128 v[56:59], v200 offset:8192
    v_mfma_f32_16x16x32_bf16 v[32:35], v[80:83], v[196:199], v[32:35]
    ds_read_b128 v[60:63], v200 offset:9216
    v_mfma_f32_16x16x32_bf16 v[12:15], v[84:87], v[180:183], v[12:15]
    ds_read_b128 v[64:67], v200 offset:10240
    v_mfma_f32_16x16x32_bf16 v[36:39], v[84:87], v[196:199], v[36:39]
    ds_read_b128 v[68:71], v200 offset:11264
    v_mfma_f32_16x16x32_bf16 v[16:19], v[88:91], v[180:183], v[16:19]
    ds_read_b128 v[72:75], v200 offset:12288
    v_mfma_f32_16x16x32_bf16 v[40:43], v[88:91], v[196:199], v[40:43]
    ds_read_b128 v[76:79], v200 offset:13312
    v_mfma_f32_16x16x32_bf16 v[20:23], v[92:95], v[180:183], v[20:23]
    v_mfma_f32_16x16x32_bf16 v[44:47], v[92:95], v[196:199], v[44:47]
    buffer_load_dwordx4 v[164:167], v1, s[12:15], s41 offen offset:3072 sc1
    v_mfma_f32_16x16x32_bf16 v[24:27], v[96:99], v[180:183], v[24:27]
    v_mfma_f32_16x16x32_bf16 v[48:51], v[96:99], v[196:199], v[48:51]
    s_add_u32 s40, s40, 4096
    v_mfma_f32_16x16x32_bf16 v[28:31], v[100:103], v[180:183], v[28:31]
    v_mfma_f32_16x16x32_bf16 v[52:55], v[100:103], v[196:199], v[52:55]
    s_add_u32 s41, s41, 4096
    s_waitcnt vmcnt(15)
    s_waitcnt lgkmcnt(0)
    v_mfma_f32_16x16x32_bf16 v[8:11], v[56:59], v[104:107], v[8:11]
    ds_read_b128 v[80:83], v200 offset:14336
    v_mfma_f32_16x16x32_bf16 v[32:35], v[56:59], v[120:123], v[32:35]
    ds_read_b128 v[84:87], v200 offset:15360
    v_mfma_f32_16x16x32_bf16 v[12:15], v[60:63], v[104:107], v[12:15]
    ds_read_b128 v[88:91], v200 offset:16384
    v_mfma_f32_16x16x32_bf16 v[36:39], v[60:63], v[120:123], v[36:39]
    ds_read_b128 v[92:95], v200 offset:17408
    v_mfma_f32_16x16x32_bf16 v[16:19], v[64:67], v[104:107], v[16:19]
    ds_read_b128 v[96:99], v200 offset:18432
    v_mfma_f32_16x16x32_bf16 v[40:43], v[64:67], v[120:123], v[40:43]
    ds_read_b128 v[100:103], v200 offset:19456
    v_mfma_f32_16x16x32_bf16 v[20:23], v[68:71], v[104:107], v[20:23]
    v_mfma_f32_16x16x32_bf16 v[44:47], v[68:71], v[120:123], v[44:47]
    buffer_load_dwordx4 a[120:123], v1, s[16:19], s44 offen offset:2048
    v_mfma_f32_16x16x32_bf16 v[24:27], v[72:75], v[104:107], v[24:27]
    v_mfma_f32_16x16x32_bf16 v[48:51], v[72:75], v[120:123], v[48:51]
    buffer_load_dwordx4 a[124:127], v1, s[16:19], s45 offen offset:2048
    v_mfma_f32_16x16x32_bf16 v[28:31], v[76:79], v[104:107], v[28:31]
    v_mfma_f32_16x16x32_bf16 v[52:55], v[76:79], v[120:123], v[52:55]
    buffer_load_dwordx4 a[128:131], v1, s[16:19], s46 offen offset:2048
    s_waitcnt lgkmcnt(0)
    v_mfma_f32_16x16x32_bf16 v[8:11], v[80:83], v[108:111], v[8:11]
    ds_read_b128 v[56:59], v200 offset:20480
    v_mfma_f32_16x16x32_bf16 v[32:35], v[80:83], v[124:127], v[32:35]
    ds_read_b128 v[60:63], v200 offset:21504
    v_mfma_f32_16x16x32_bf16 v[12:15], v[84:87], v[108:111], v[12:15]
    ds_read_b128 v[64:67], v200 offset:22528
    v_mfma_f32_16x16x32_bf16 v[36:39], v[84:87], v[124:127], v[36:39]
    ds_read_b128 v[68:71], v200 offset:23552
    v_mfma_f32_16x16x32_bf16 v[16:19], v[88:91], v[108:111], v[16:19]
    ds_read_b128 v[72:75], v200 offset:24576
    v_mfma_f32_16x16x32_bf16 v[40:43], v[88:91], v[124:127], v[40:43]
    ds_read_b128 v[76:79], v200 offset:25600
    v_mfma_f32_16x16x32_bf16 v[20:23], v[92:95], v[108:111], v[20:23]
    v_mfma_f32_16x16x32_bf16 v[44:47], v[92:95], v[124:127], v[44:47]
    buffer_load_dwordx4 a[132:135], v1, s[16:19], s47 offen offset:2048
    v_mfma_f32_16x16x32_bf16 v[24:27], v[96:99], v[108:111], v[24:27]
    v_mfma_f32_16x16x32_bf16 v[48:51], v[96:99], v[124:127], v[48:51]
    buffer_load_dwordx4 a[136:139], v1, s[16:19], s48 offen offset:2048
    v_mfma_f32_16x16x32_bf16 v[28:31], v[100:103], v[108:111], v[28:31]
    v_mfma_f32_16x16x32_bf16 v[52:55], v[100:103], v[124:127], v[52:55]
    v_lshlrev_b32 v203, 4, v202
    s_waitcnt lgkmcnt(0)
    v_mfma_f32_16x16x32_bf16 v[8:11], v[56:59], v[112:115], v[8:11]
    ds_read_b128 v[80:83], v200 offset:26624
    v_mfma_f32_16x16x32_bf16 v[32:35], v[56:59], v[128:131], v[32:35]
    ds_read_b128 v[84:87], v200 offset:27648
    v_mfma_f32_16x16x32_bf16 v[12:15], v[60:63], v[112:115], v[12:15]
    ds_read_b128 v[88:91], v200 offset:28672
    v_mfma_f32_16x16x32_bf16 v[36:39], v[60:63], v[128:131], v[36:39]
    ds_read_b128 v[92:95], v200 offset:29696
    v_mfma_f32_16x16x32_bf16 v[16:19], v[64:67], v[112:115], v[16:19]
    ds_read_b128 v[96:99], v200 offset:30720
    v_mfma_f32_16x16x32_bf16 v[40:43], v[64:67], v[128:131], v[40:43]
    ds_read_b128 v[100:103], v200 offset:31744
    v_mfma_f32_16x16x32_bf16 v[20:23], v[68:71], v[112:115], v[20:23]
    v_mfma_f32_16x16x32_bf16 v[44:47], v[68:71], v[128:131], v[44:47]
    s_mul_i32 s66, s65, 384
    v_mfma_f32_16x16x32_bf16 v[24:27], v[72:75], v[112:115], v[24:27]
    v_mfma_f32_16x16x32_bf16 v[48:51], v[72:75], v[128:131], v[48:51]
    buffer_load_dwordx4 v[168:171], v203, s[56:59], s66 offen offset:0
    v_mfma_f32_16x16x32_bf16 v[28:31], v[76:79], v[112:115], v[28:31]
    v_mfma_f32_16x16x32_bf16 v[52:55], v[76:79], v[128:131], v[52:55]
    buffer_load_dwordx4 v[172:175], v203, s[56:59], s66 offen offset:64
    s_waitcnt lgkmcnt(0)
    v_mfma_f32_16x16x32_bf16 v[8:11], v[80:83], v[116:119], v[8:11]
    ds_read_b128 v[56:59], v200 offset:32768
    v_mfma_f32_16x16x32_bf16 v[32:35], v[80:83], v[132:135], v[32:35]
    ds_read_b128 v[60:63], v200 offset:33792
    v_mfma_f32_16x16x32_bf16 v[12:15], v[84:87], v[116:119], v[12:15]
    ds_read_b128 v[64:67], v200 offset:34816
    v_mfma_f32_16x16x32_bf16 v[36:39], v[84:87], v[132:135], v[36:39]
    ds_read_b128 v[68:71], v200 offset:35840
    v_mfma_f32_16x16x32_bf16 v[16:19], v[88:91], v[116:119], v[16:19]
    ds_read_b128 v[72:75], v200 offset:36864
    v_mfma_f32_16x16x32_bf16 v[40:43], v[88:91], v[132:135], v[40:43]
    ds_read_b128 v[76:79], v200 offset:37888
    v_mfma_f32_16x16x32_bf16 v[20:23], v[92:95], v[116:119], v[20:23]
    v_mfma_f32_16x16x32_bf16 v[44:47], v[92:95], v[132:135], v[44:47]
    buffer_load_dwordx4 v[176:179], v203, s[56:59], s66 offen offset:128
    v_mfma_f32_16x16x32_bf16 v[24:27], v[96:99], v[116:119], v[24:27]
    buffer_load_dwordx4 v[180:183], v203, s[56:59], s66 offen offset:192
    v_mfma_f32_16x16x32_bf16 v[48:51], v[96:99], v[132:135], v[48:51]
    v_mfma_f32_16x16x32_bf16 v[28:31], v[100:103], v[116:119], v[28:31]
    buffer_load_dwordx4 v[184:187], v203, s[56:59], s66 offen offset:256
    v_mfma_f32_16x16x32_bf16 v[52:55], v[100:103], v[132:135], v[52:55]
    buffer_load_dwordx4 v[188:191], v203, s[56:59], s66 offen offset:320
    s_waitcnt vmcnt(11)
    s_waitcnt lgkmcnt(0)
    v_mfma_f32_16x16x32_bf16 v[8:11], v[56:59], v[136:139], v[8:11]
    ds_read_b128 v[80:83], v200 offset:38912
    v_mfma_f32_16x16x32_bf16 v[32:35], v[56:59], v[152:155], v[32:35]
    ds_read_b128 v[84:87], v200 offset:39936
    v_mfma_f32_16x16x32_bf16 v[12:15], v[60:63], v[136:139], v[12:15]
    ds_read_b128 v[88:91], v200 offset:40960
    v_mfma_f32_16x16x32_bf16 v[36:39], v[60:63], v[152:155], v[36:39]
    ds_read_b128 v[92:95], v200 offset:41984
    v_mfma_f32_16x16x32_bf16 v[16:19], v[64:67], v[136:139], v[16:19]
    ds_read_b128 v[96:99], v200 offset:43008
    v_mfma_f32_16x16x32_bf16 v[40:43], v[64:67], v[152:155], v[40:43]
    ds_read_b128 v[100:103], v200 offset:44032
    v_mfma_f32_16x16x32_bf16 v[20:23], v[68:71], v[136:139], v[20:23]
    v_mfma_f32_16x16x32_bf16 v[44:47], v[68:71], v[152:155], v[44:47]
    v_mfma_f32_16x16x32_bf16 v[24:27], v[72:75], v[136:139], v[24:27]
    v_mfma_f32_16x16x32_bf16 v[48:51], v[72:75], v[152:155], v[48:51]
    v_mfma_f32_16x16x32_bf16 v[28:31], v[76:79], v[136:139], v[28:31]
    v_mfma_f32_16x16x32_bf16 v[52:55], v[76:79], v[152:155], v[52:55]
    s_waitcnt lgkmcnt(0)
    v_mfma_f32_16x16x32_bf16 v[8:11], v[80:83], v[140:143], v[8:11]
    ds_read_b128 v[56:59], v200 offset:45056
    v_mfma_f32_16x16x32_bf16 v[32:35], v[80:83], v[156:159], v[32:35]
    ds_read_b128 v[60:63], v200 offset:46080
    v_mfma_f32_16x16x32_bf16 v[12:15], v[84:87], v[140:143], v[12:15]
    ds_read_b128 v[64:67], v200 offset:47104
    v_mfma_f32_16x16x32_bf16 v[36:39], v[84:87], v[156:159], v[36:39]
    ds_read_b128 v[68:71], v200 offset:48128
    v_mfma_f32_16x16x32_bf16 v[16:19], v[88:91], v[140:143], v[16:19]
    ds_read_b128 v[72:75], v200 offset:49152
    v_mfma_f32_16x16x32_bf16 v[40:43], v[88:91], v[156:159], v[40:43]
    ds_read_b128 v[76:79], v200 offset:50176
    v_mfma_f32_16x16x32_bf16 v[20:23], v[92:95], v[140:143], v[20:23]
    v_mfma_f32_16x16x32_bf16 v[44:47], v[92:95], v[156:159], v[44:47]
    v_mfma_f32_16x16x32_bf16 v[24:27], v[96:99], v[140:143], v[24:27]
    v_mfma_f32_16x16x32_bf16 v[48:51], v[96:99], v[156:159], v[48:51]
    v_mfma_f32_16x16x32_bf16 v[28:31], v[100:103], v[140:143], v[28:31]
    v_mfma_f32_16x16x32_bf16 v[52:55], v[100:103], v[156:159], v[52:55]
    s_waitcnt lgkmcnt(0)
    v_mfma_f32_16x16x32_bf16 v[8:11], v[56:59], v[144:147], v[8:11]
    ds_read_b128 v[80:83], v200 offset:51200
    v_mfma_f32_16x16x32_bf16 v[32:35], v[56:59], v[160:163], v[32:35]
    ds_read_b128 v[84:87], v200 offset:52224
    v_mfma_f32_16x16x32_bf16 v[12:15], v[60:63], v[144:147], v[12:15]
    ds_read_b128 v[88:91], v200 offset:53248
    v_mfma_f32_16x16x32_bf16 v[36:39], v[60:63], v[160:163], v[36:39]
    ds_read_b128 v[92:95], v200 offset:54272
    v_mfma_f32_16x16x32_bf16 v[16:19], v[64:67], v[144:147], v[16:19]
    ds_read_b128 v[96:99], v200 offset:55296
    v_mfma_f32_16x16x32_bf16 v[40:43], v[64:67], v[160:163], v[40:43]
    ds_read_b128 v[100:103], v200 offset:56320
    v_mfma_f32_16x16x32_bf16 v[20:23], v[68:71], v[144:147], v[20:23]
    v_mfma_f32_16x16x32_bf16 v[44:47], v[68:71], v[160:163], v[44:47]
    v_mfma_f32_16x16x32_bf16 v[24:27], v[72:75], v[144:147], v[24:27]
    v_mfma_f32_16x16x32_bf16 v[48:51], v[72:75], v[160:163], v[48:51]
    v_mfma_f32_16x16x32_bf16 v[28:31], v[76:79], v[144:147], v[28:31]
    v_mfma_f32_16x16x32_bf16 v[52:55], v[76:79], v[160:163], v[52:55]
    s_waitcnt lgkmcnt(0)
    v_mfma_f32_16x16x32_bf16 v[8:11], v[80:83], v[148:151], v[8:11]
    v_mfma_f32_16x16x32_bf16 v[32:35], v[80:83], v[164:167], v[32:35]
    v_mfma_f32_16x16x32_bf16 v[12:15], v[84:87], v[148:151], v[12:15]
    v_mfma_f32_16x16x32_bf16 v[36:39], v[84:87], v[164:167], v[36:39]
    v_mfma_f32_16x16x32_bf16 v[16:19], v[88:91], v[148:151], v[16:19]
    v_mfma_f32_16x16x32_bf16 v[40:43], v[88:91], v[164:167], v[40:43]
    v_mfma_f32_16x16x32_bf16 v[20:23], v[92:95], v[148:151], v[20:23]
    v_mfma_f32_16x16x32_bf16 v[44:47], v[92:95], v[164:167], v[44:47]
    v_mfma_f32_16x16x32_bf16 v[24:27], v[96:99], v[148:151], v[24:27]
    v_mfma_f32_16x16x32_bf16 v[48:51], v[96:99], v[164:167], v[48:51]
    v_mfma_f32_16x16x32_bf16 v[28:31], v[100:103], v[148:151], v[28:31]
    v_mfma_f32_16x16x32_bf16 v[52:55], v[100:103], v[164:167], v[52:55]
    s_waitcnt vmcnt(0)
    v_add_f32 v204, v204, v206
    v_add_f32 v205, v205, v207
    v_add_f32 v208, v208, v210
    v_add_f32 v209, v209, v211
    v_mov_b32 v56, v204
    s_nop 1
    v_permlane32_swap_b32 v204, v56
    v_add_f32 v204, v204, v56
    v_mov_b32 v56, v204
    s_nop 1
    v_permlane16_swap_b32 v204, v56
    v_add_f32 v204, v204, v56
    v_mov_b32 v57, v205
    s_nop 1
    v_permlane32_swap_b32 v205, v57
    v_add_f32 v205, v205, v57
    v_mov_b32 v57, v205
    s_nop 1
    v_permlane16_swap_b32 v205, v57
    v_add_f32 v205, v205, v57
    v_mov_b32 v56, v208
    s_nop 1
    v_permlane32_swap_b32 v208, v56
    v_add_f32 v208, v208, v56
    v_mov_b32 v56, v208
    s_nop 1
    v_permlane16_swap_b32 v208, v56
    v_add_f32 v208, v208, v56
    v_mov_b32 v57, v209
    s_nop 1
    v_permlane32_swap_b32 v209, v57
    v_add_f32 v209, v209, v57
    v_mov_b32 v57, v209
    s_nop 1
    v_permlane16_swap_b32 v209, v57
    v_add_f32 v209, v209, v57
    s_mov_b32 s66, 0x3acccccd
    s_mov_b32 s67, 0x3727c5ac
    v_mul_f32 v204, s66, v204
    v_mul_f32 v205, s66, v205
    v_fma_f32 v205, -v204, v204, v205
    v_max_f32 v205, 0, v205
    v_add_f32 v205, s67, v205
    v_rsq_f32 v224, v205
    s_nop 0
    v_mul_f32 v225, v204, v224
    v_mul_f32 v208, s66, v208
    v_mul_f32 v209, s66, v209
    v_fma_f32 v209, -v208, v208, v209
    v_max_f32 v209, 0, v209
    v_add_f32 v209, s67, v209
    v_rsq_f32 v226, v209
    s_nop 0
    v_mul_f32 v227, v208, v226
    v_mov_b32 v228, 0xc0135761
    v_mov_b32 v229, 0xc0135761
    s_mov_b32 s40, 0xbdd2d3e8
    s_mov_b32 s41, 0xbdd2d3e8
    s_mov_b32 s42, 1.0
    s_mov_b32 s43, 1.0
    s_mul_i32 s66, s50, 48
    s_mul_i32 s67, s65, 3
    s_add_u32 s66, s66, s67
    s_lshl_b32 s66, s66, 10
    s_add_u32 s67, s66, 49152
    v_lshlrev_b32 v56, 16, v212
    v_and_b32 v57, 0xffff0000, v212
    v_lshlrev_b32 v58, 16, v213
    v_and_b32 v59, 0xffff0000, v213
    v_lshlrev_b32 v60, 16, v214
    v_and_b32 v61, 0xffff0000, v214
    v_lshlrev_b32 v62, 16, v215
    v_and_b32 v63, 0xffff0000, v215
    v_pk_fma_f32 v[80:81], v[168:169], v[224:225], v[56:57] op_sel:[0,1,0] op_sel_hi:[1,1,1] neg_lo:[1,0,0] neg_hi:[1,0,0]
    v_pk_fma_f32 v[82:83], v[170:171], v[224:225], v[58:59] op_sel:[0,1,0] op_sel_hi:[1,1,1] neg_lo:[1,0,0] neg_hi:[1,0,0]
    v_pk_fma_f32 v[84:85], v[172:173], v[224:225], v[60:61] op_sel:[0,1,0] op_sel_hi:[1,1,1] neg_lo:[1,0,0] neg_hi:[1,0,0]
    v_pk_fma_f32 v[86:87], v[174:175], v[224:225], v[62:63] op_sel:[0,1,0] op_sel_hi:[1,1,1] neg_lo:[1,0,0] neg_hi:[1,0,0]
    v_pk_fma_f32 v[88:89], v[168:169], v[226:227], v[56:57] op_sel:[0,1,0] op_sel_hi:[1,1,1] neg_lo:[1,0,0] neg_hi:[1,0,0]
    v_pk_fma_f32 v[90:91], v[170:171], v[226:227], v[58:59] op_sel:[0,1,0] op_sel_hi:[1,1,1] neg_lo:[1,0,0] neg_hi:[1,0,0]
    v_pk_fma_f32 v[92:93], v[172:173], v[226:227], v[60:61] op_sel:[0,1,0] op_sel_hi:[1,1,1] neg_lo:[1,0,0] neg_hi:[1,0,0]
    v_pk_fma_f32 v[94:95], v[174:175], v[226:227], v[62:63] op_sel:[0,1,0] op_sel_hi:[1,1,1] neg_lo:[1,0,0] neg_hi:[1,0,0]
    v_pk_fma_f32 v[64:65], v[8:9], v[224:225], v[80:81] op_sel:[0,0,0] op_sel_hi:[1,0,1]
    v_pk_fma_f32 v[66:67], v[10:11], v[224:225], v[82:83] op_sel:[0,0,0] op_sel_hi:[1,0,1]
    v_pk_fma_f32 v[68:69], v[12:13], v[224:225], v[84:85] op_sel:[0,0,0] op_sel_hi:[1,0,1]
    v_pk_fma_f32 v[70:71], v[14:15], v[224:225], v[86:87] op_sel:[0,0,0] op_sel_hi:[1,0,1]
    v_pk_fma_f32 v[72:73], v[32:33], v[226:227], v[88:89] op_sel:[0,0,0] op_sel_hi:[1,0,1]
    v_pk_fma_f32 v[74:75], v[34:35], v[226:227], v[90:91] op_sel:[0,0,0] op_sel_hi:[1,0,1]
    v_pk_fma_f32 v[76:77], v[36:37], v[226:227], v[92:93] op_sel:[0,0,0] op_sel_hi:[1,0,1]
    v_pk_fma_f32 v[78:79], v[38:39], v[226:227], v[94:95] op_sel:[0,0,0] op_sel_hi:[1,0,1]
    v_pk_mul_f32 v[80:81], v[64:65], v[64:65]
    v_pk_mul_f32 v[82:83], v[66:67], v[66:67]
    v_pk_mul_f32 v[84:85], v[68:69], v[68:69]
    v_pk_mul_f32 v[86:87], v[70:71], v[70:71]
    v_pk_mul_f32 v[88:89], v[72:73], v[72:73]
    v_pk_mul_f32 v[90:91], v[74:75], v[74:75]
    v_pk_mul_f32 v[92:93], v[76:77], v[76:77]
    v_pk_mul_f32 v[94:95], v[78:79], v[78:79]
    v_pk_fma_f32 v[80:81], v[80:81], s[40:41], v[228:229]
    v_pk_fma_f32 v[82:83], v[82:83], s[40:41], v[228:229]
    v_pk_fma_f32 v[84:85], v[84:85], s[40:41], v[228:229]
    v_pk_fma_f32 v[86:87], v[86:87], s[40:41], v[228:229]
    v_pk_fma_f32 v[88:89], v[88:89], s[40:41], v[228:229]
    v_pk_fma_f32 v[90:91], v[90:91], s[40:41], v[228:229]
    v_pk_fma_f32 v[92:93], v[92:93], s[40:41], v[228:229]
    v_pk_fma_f32 v[94:95], v[94:95], s[40:41], v[228:229]
    v_pk_mul_f32 v[80:81], v[80:81], v[64:65]
    v_pk_mul_f32 v[82:83], v[82:83], v[66:67]
    v_pk_mul_f32 v[84:85], v[84:85], v[68:69]
    v_pk_mul_f32 v[86:87], v[86:87], v[70:71]
    v_pk_mul_f32 v[88:89], v[88:89], v[72:73]
    v_pk_mul_f32 v[90:91], v[90:91], v[74:75]
    v_pk_mul_f32 v[92:93], v[92:93], v[76:77]
    v_pk_mul_f32 v[94:95], v[94:95], v[78:79]
    v_exp_f32 v80, v80
    v_exp_f32 v81, v81
    v_exp_f32 v82, v82
    v_exp_f32 v83, v83
    v_exp_f32 v84, v84
    v_exp_f32 v85, v85
    v_exp_f32 v86, v86
    v_exp_f32 v87, v87
    v_exp_f32 v88, v88
    v_exp_f32 v89, v89
    v_exp_f32 v90, v90
    v_exp_f32 v91, v91
    v_exp_f32 v92, v92
    v_exp_f32 v93, v93
    v_exp_f32 v94, v94
    v_exp_f32 v95, v95
    v_pk_add_f32 v[80:81], v[80:81], s[42:43]
    v_pk_add_f32 v[82:83], v[82:83], s[42:43]
    v_pk_add_f32 v[84:85], v[84:85], s[42:43]
    v_pk_add_f32 v[86:87], v[86:87], s[42:43]
    v_pk_add_f32 v[88:89], v[88:89], s[42:43]
    v_pk_add_f32 v[90:91], v[90:91], s[42:43]
    v_pk_add_f32 v[92:93], v[92:93], s[42:43]
    v_pk_add_f32 v[94:95], v[94:95], s[42:43]
    v_rcp_f32 v80, v80
    v_rcp_f32 v81, v81
    v_rcp_f32 v82, v82
    v_rcp_f32 v83, v83
    v_rcp_f32 v84, v84
    v_rcp_f32 v85, v85
    v_rcp_f32 v86, v86
    v_rcp_f32 v87, v87
    v_rcp_f32 v88, v88
    v_rcp_f32 v89, v89
    v_rcp_f32 v90, v90
    v_rcp_f32 v91, v91
    v_rcp_f32 v92, v92
    v_rcp_f32 v93, v93
    v_rcp_f32 v94, v94
    v_rcp_f32 v95, v95
    v_pk_mul_f32 v[64:65], v[64:65], v[80:81]
    v_pk_mul_f32 v[66:67], v[66:67], v[82:83]
    v_pk_mul_f32 v[68:69], v[68:69], v[84:85]
    v_pk_mul_f32 v[70:71], v[70:71], v[86:87]
    v_pk_mul_f32 v[72:73], v[72:73], v[88:89]
    v_pk_mul_f32 v[74:75], v[74:75], v[90:91]
    v_pk_mul_f32 v[76:77], v[76:77], v[92:93]
    v_pk_mul_f32 v[78:79], v[78:79], v[94:95]
    v_cvt_pk_bf16_f32 v104, v64, v65
    v_cvt_pk_bf16_f32 v105, v66, v67
    v_cvt_pk_bf16_f32 v106, v68, v69
    v_cvt_pk_bf16_f32 v107, v70, v71
    buffer_store_dwordx4 v[104:107], v1, s[20:23], s66 offen offset:0 sc1
    v_cvt_pk_bf16_f32 v108, v72, v73
    v_cvt_pk_bf16_f32 v109, v74, v75
    v_cvt_pk_bf16_f32 v110, v76, v77
    v_cvt_pk_bf16_f32 v111, v78, v79
    buffer_store_dwordx4 v[108:111], v1, s[20:23], s67 offen offset:0 sc1
    v_lshlrev_b32 v56, 16, v216
    v_and_b32 v57, 0xffff0000, v216
    v_lshlrev_b32 v58, 16, v217
    v_and_b32 v59, 0xffff0000, v217
    v_lshlrev_b32 v60, 16, v218
    v_and_b32 v61, 0xffff0000, v218
    v_lshlrev_b32 v62, 16, v219
    v_and_b32 v63, 0xffff0000, v219
    v_pk_fma_f32 v[80:81], v[176:177], v[224:225], v[56:57] op_sel:[0,1,0] op_sel_hi:[1,1,1] neg_lo:[1,0,0] neg_hi:[1,0,0]
    v_pk_fma_f32 v[82:83], v[178:179], v[224:225], v[58:59] op_sel:[0,1,0] op_sel_hi:[1,1,1] neg_lo:[1,0,0] neg_hi:[1,0,0]
    v_pk_fma_f32 v[84:85], v[180:181], v[224:225], v[60:61] op_sel:[0,1,0] op_sel_hi:[1,1,1] neg_lo:[1,0,0] neg_hi:[1,0,0]
    v_pk_fma_f32 v[86:87], v[182:183], v[224:225], v[62:63] op_sel:[0,1,0] op_sel_hi:[1,1,1] neg_lo:[1,0,0] neg_hi:[1,0,0]
    v_pk_fma_f32 v[88:89], v[176:177], v[226:227], v[56:57] op_sel:[0,1,0] op_sel_hi:[1,1,1] neg_lo:[1,0,0] neg_hi:[1,0,0]
    v_pk_fma_f32 v[90:91], v[178:179], v[226:227], v[58:59] op_sel:[0,1,0] op_sel_hi:[1,1,1] neg_lo:[1,0,0] neg_hi:[1,0,0]
    v_pk_fma_f32 v[92:93], v[180:181], v[226:227], v[60:61] op_sel:[0,1,0] op_sel_hi:[1,1,1] neg_lo:[1,0,0] neg_hi:[1,0,0]
    v_pk_fma_f32 v[94:95], v[182:183], v[226:227], v[62:63] op_sel:[0,1,0] op_sel_hi:[1,1,1] neg_lo:[1,0,0] neg_hi:[1,0,0]
    v_pk_fma_f32 v[64:65], v[16:17], v[224:225], v[80:81] op_sel:[0,0,0] op_sel_hi:[1,0,1]
    v_pk_fma_f32 v[66:67], v[18:19], v[224:225], v[82:83] op_sel:[0,0,0] op_sel_hi:[1,0,1]
    v_pk_fma_f32 v[68:69], v[20:21], v[224:225], v[84:85] op_sel:[0,0,0] op_sel_hi:[1,0,1]
    v_pk_fma_f32 v[70:71], v[22:23], v[224:225], v[86:87] op_sel:[0,0,0] op_sel_hi:[1,0,1]
    v_pk_fma_f32 v[72:73], v[40:41], v[226:227], v[88:89] op_sel:[0,0,0] op_sel_hi:[1,0,1]
    v_pk_fma_f32 v[74:75], v[42:43], v[226:227], v[90:91] op_sel:[0,0,0] op_sel_hi:[1,0,1]
    v_pk_fma_f32 v[76:77], v[44:45], v[226:227], v[92:93] op_sel:[0,0,0] op_sel_hi:[1,0,1]
    v_pk_fma_f32 v[78:79], v[46:47], v[226:227], v[94:95] op_sel:[0,0,0] op_sel_hi:[1,0,1]
    v_pk_mul_f32 v[80:81], v[64:65], v[64:65]
    v_pk_mul_f32 v[82:83], v[66:67], v[66:67]
    v_pk_mul_f32 v[84:85], v[68:69], v[68:69]
    v_pk_mul_f32 v[86:87], v[70:71], v[70:71]
    v_pk_mul_f32 v[88:89], v[72:73], v[72:73]
    v_pk_mul_f32 v[90:91], v[74:75], v[74:75]
    v_pk_mul_f32 v[92:93], v[76:77], v[76:77]
    v_pk_mul_f32 v[94:95], v[78:79], v[78:79]
    v_pk_fma_f32 v[80:81], v[80:81], s[40:41], v[228:229]
    v_pk_fma_f32 v[82:83], v[82:83], s[40:41], v[228:229]
    v_pk_fma_f32 v[84:85], v[84:85], s[40:41], v[228:229]
    v_pk_fma_f32 v[86:87], v[86:87], s[40:41], v[228:229]
    v_pk_fma_f32 v[88:89], v[88:89], s[40:41], v[228:229]
    v_pk_fma_f32 v[90:91], v[90:91], s[40:41], v[228:229]
    v_pk_fma_f32 v[92:93], v[92:93], s[40:41], v[228:229]
    v_pk_fma_f32 v[94:95], v[94:95], s[40:41], v[228:229]
    v_pk_mul_f32 v[80:81], v[80:81], v[64:65]
    v_pk_mul_f32 v[82:83], v[82:83], v[66:67]
    v_pk_mul_f32 v[84:85], v[84:85], v[68:69]
    v_pk_mul_f32 v[86:87], v[86:87], v[70:71]
    v_pk_mul_f32 v[88:89], v[88:89], v[72:73]
    v_pk_mul_f32 v[90:91], v[90:91], v[74:75]
    v_pk_mul_f32 v[92:93], v[92:93], v[76:77]
    v_pk_mul_f32 v[94:95], v[94:95], v[78:79]
    v_exp_f32 v80, v80
    v_exp_f32 v81, v81
    v_exp_f32 v82, v82
    v_exp_f32 v83, v83
    v_exp_f32 v84, v84
    v_exp_f32 v85, v85
    v_exp_f32 v86, v86
    v_exp_f32 v87, v87
    v_exp_f32 v88, v88
    v_exp_f32 v89, v89
    v_exp_f32 v90, v90
    v_exp_f32 v91, v91
    v_exp_f32 v92, v92
    v_exp_f32 v93, v93
    v_exp_f32 v94, v94
    v_exp_f32 v95, v95
    v_pk_add_f32 v[80:81], v[80:81], s[42:43]
    v_pk_add_f32 v[82:83], v[82:83], s[42:43]
    v_pk_add_f32 v[84:85], v[84:85], s[42:43]
    v_pk_add_f32 v[86:87], v[86:87], s[42:43]
    v_pk_add_f32 v[88:89], v[88:89], s[42:43]
    v_pk_add_f32 v[90:91], v[90:91], s[42:43]
    v_pk_add_f32 v[92:93], v[92:93], s[42:43]
    v_pk_add_f32 v[94:95], v[94:95], s[42:43]
    v_rcp_f32 v80, v80
    v_rcp_f32 v81, v81
    v_rcp_f32 v82, v82
    v_rcp_f32 v83, v83
    v_rcp_f32 v84, v84
    v_rcp_f32 v85, v85
    v_rcp_f32 v86, v86
    v_rcp_f32 v87, v87
    v_rcp_f32 v88, v88
    v_rcp_f32 v89, v89
    v_rcp_f32 v90, v90
    v_rcp_f32 v91, v91
    v_rcp_f32 v92, v92
    v_rcp_f32 v93, v93
    v_rcp_f32 v94, v94
    v_rcp_f32 v95, v95
    v_pk_mul_f32 v[64:65], v[64:65], v[80:81]
    v_pk_mul_f32 v[66:67], v[66:67], v[82:83]
    v_pk_mul_f32 v[68:69], v[68:69], v[84:85]
    v_pk_mul_f32 v[70:71], v[70:71], v[86:87]
    v_pk_mul_f32 v[72:73], v[72:73], v[88:89]
    v_pk_mul_f32 v[74:75], v[74:75], v[90:91]
    v_pk_mul_f32 v[76:77], v[76:77], v[92:93]
    v_pk_mul_f32 v[78:79], v[78:79], v[94:95]
    v_cvt_pk_bf16_f32 v112, v64, v65
    v_cvt_pk_bf16_f32 v113, v66, v67
    v_cvt_pk_bf16_f32 v114, v68, v69
    v_cvt_pk_bf16_f32 v115, v70, v71
    buffer_store_dwordx4 v[112:115], v1, s[20:23], s66 offen offset:1024 sc1
    v_cvt_pk_bf16_f32 v116, v72, v73
    v_cvt_pk_bf16_f32 v117, v74, v75
    v_cvt_pk_bf16_f32 v118, v76, v77
    v_cvt_pk_bf16_f32 v119, v78, v79
    buffer_store_dwordx4 v[116:119], v1, s[20:23], s67 offen offset:1024 sc1
    v_lshlrev_b32 v56, 16, v220
    v_and_b32 v57, 0xffff0000, v220
    v_lshlrev_b32 v58, 16, v221
    v_and_b32 v59, 0xffff0000, v221
    v_lshlrev_b32 v60, 16, v222
    v_and_b32 v61, 0xffff0000, v222
    v_lshlrev_b32 v62, 16, v223
    v_and_b32 v63, 0xffff0000, v223
    v_pk_fma_f32 v[80:81], v[184:185], v[224:225], v[56:57] op_sel:[0,1,0] op_sel_hi:[1,1,1] neg_lo:[1,0,0] neg_hi:[1,0,0]
    v_pk_fma_f32 v[82:83], v[186:187], v[224:225], v[58:59] op_sel:[0,1,0] op_sel_hi:[1,1,1] neg_lo:[1,0,0] neg_hi:[1,0,0]
    v_pk_fma_f32 v[84:85], v[188:189], v[224:225], v[60:61] op_sel:[0,1,0] op_sel_hi:[1,1,1] neg_lo:[1,0,0] neg_hi:[1,0,0]
    v_pk_fma_f32 v[86:87], v[190:191], v[224:225], v[62:63] op_sel:[0,1,0] op_sel_hi:[1,1,1] neg_lo:[1,0,0] neg_hi:[1,0,0]
    v_pk_fma_f32 v[88:89], v[184:185], v[226:227], v[56:57] op_sel:[0,1,0] op_sel_hi:[1,1,1] neg_lo:[1,0,0] neg_hi:[1,0,0]
    v_pk_fma_f32 v[90:91], v[186:187], v[226:227], v[58:59] op_sel:[0,1,0] op_sel_hi:[1,1,1] neg_lo:[1,0,0] neg_hi:[1,0,0]
    v_pk_fma_f32 v[92:93], v[188:189], v[226:227], v[60:61] op_sel:[0,1,0] op_sel_hi:[1,1,1] neg_lo:[1,0,0] neg_hi:[1,0,0]
    v_pk_fma_f32 v[94:95], v[190:191], v[226:227], v[62:63] op_sel:[0,1,0] op_sel_hi:[1,1,1] neg_lo:[1,0,0] neg_hi:[1,0,0]
    v_pk_fma_f32 v[64:65], v[24:25], v[224:225], v[80:81] op_sel:[0,0,0] op_sel_hi:[1,0,1]
    v_pk_fma_f32 v[66:67], v[26:27], v[224:225], v[82:83] op_sel:[0,0,0] op_sel_hi:[1,0,1]
    v_pk_fma_f32 v[68:69], v[28:29], v[224:225], v[84:85] op_sel:[0,0,0] op_sel_hi:[1,0,1]
    v_pk_fma_f32 v[70:71], v[30:31], v[224:225], v[86:87] op_sel:[0,0,0] op_sel_hi:[1,0,1]
    v_pk_fma_f32 v[72:73], v[48:49], v[226:227], v[88:89] op_sel:[0,0,0] op_sel_hi:[1,0,1]
    v_pk_fma_f32 v[74:75], v[50:51], v[226:227], v[90:91] op_sel:[0,0,0] op_sel_hi:[1,0,1]
    v_pk_fma_f32 v[76:77], v[52:53], v[226:227], v[92:93] op_sel:[0,0,0] op_sel_hi:[1,0,1]
    v_pk_fma_f32 v[78:79], v[54:55], v[226:227], v[94:95] op_sel:[0,0,0] op_sel_hi:[1,0,1]
    v_pk_mul_f32 v[80:81], v[64:65], v[64:65]
    v_pk_mul_f32 v[82:83], v[66:67], v[66:67]
    v_pk_mul_f32 v[84:85], v[68:69], v[68:69]
    v_pk_mul_f32 v[86:87], v[70:71], v[70:71]
    v_pk_mul_f32 v[88:89], v[72:73], v[72:73]
    v_pk_mul_f32 v[90:91], v[74:75], v[74:75]
    v_pk_mul_f32 v[92:93], v[76:77], v[76:77]
    v_pk_mul_f32 v[94:95], v[78:79], v[78:79]
    v_pk_fma_f32 v[80:81], v[80:81], s[40:41], v[228:229]
    v_pk_fma_f32 v[82:83], v[82:83], s[40:41], v[228:229]
    v_pk_fma_f32 v[84:85], v[84:85], s[40:41], v[228:229]
    v_pk_fma_f32 v[86:87], v[86:87], s[40:41], v[228:229]
    v_pk_fma_f32 v[88:89], v[88:89], s[40:41], v[228:229]
    v_pk_fma_f32 v[90:91], v[90:91], s[40:41], v[228:229]
    v_pk_fma_f32 v[92:93], v[92:93], s[40:41], v[228:229]
    v_pk_fma_f32 v[94:95], v[94:95], s[40:41], v[228:229]
    v_pk_mul_f32 v[80:81], v[80:81], v[64:65]
    v_pk_mul_f32 v[82:83], v[82:83], v[66:67]
    v_pk_mul_f32 v[84:85], v[84:85], v[68:69]
    v_pk_mul_f32 v[86:87], v[86:87], v[70:71]
    v_pk_mul_f32 v[88:89], v[88:89], v[72:73]
    v_pk_mul_f32 v[90:91], v[90:91], v[74:75]
    v_pk_mul_f32 v[92:93], v[92:93], v[76:77]
    v_pk_mul_f32 v[94:95], v[94:95], v[78:79]
    v_exp_f32 v80, v80
    v_exp_f32 v81, v81
    v_exp_f32 v82, v82
    v_exp_f32 v83, v83
    v_exp_f32 v84, v84
    v_exp_f32 v85, v85
    v_exp_f32 v86, v86
    v_exp_f32 v87, v87
    v_exp_f32 v88, v88
    v_exp_f32 v89, v89
    v_exp_f32 v90, v90
    v_exp_f32 v91, v91
    v_exp_f32 v92, v92
    v_exp_f32 v93, v93
    v_exp_f32 v94, v94
    v_exp_f32 v95, v95
    v_pk_add_f32 v[80:81], v[80:81], s[42:43]
    v_pk_add_f32 v[82:83], v[82:83], s[42:43]
    v_pk_add_f32 v[84:85], v[84:85], s[42:43]
    v_pk_add_f32 v[86:87], v[86:87], s[42:43]
    v_pk_add_f32 v[88:89], v[88:89], s[42:43]
    v_pk_add_f32 v[90:91], v[90:91], s[42:43]
    v_pk_add_f32 v[92:93], v[92:93], s[42:43]
    v_pk_add_f32 v[94:95], v[94:95], s[42:43]
    v_rcp_f32 v80, v80
    v_rcp_f32 v81, v81
    v_rcp_f32 v82, v82
    v_rcp_f32 v83, v83
    v_rcp_f32 v84, v84
    v_rcp_f32 v85, v85
    v_rcp_f32 v86, v86
    v_rcp_f32 v87, v87
    v_rcp_f32 v88, v88
    v_rcp_f32 v89, v89
    v_rcp_f32 v90, v90
    v_rcp_f32 v91, v91
    v_rcp_f32 v92, v92
    v_rcp_f32 v93, v93
    v_rcp_f32 v94, v94
    v_rcp_f32 v95, v95
    v_pk_mul_f32 v[64:65], v[64:65], v[80:81]
    v_pk_mul_f32 v[66:67], v[66:67], v[82:83]
    v_pk_mul_f32 v[68:69], v[68:69], v[84:85]
    v_pk_mul_f32 v[70:71], v[70:71], v[86:87]
    v_pk_mul_f32 v[72:73], v[72:73], v[88:89]
    v_pk_mul_f32 v[74:75], v[74:75], v[90:91]
    v_pk_mul_f32 v[76:77], v[76:77], v[92:93]
    v_pk_mul_f32 v[78:79], v[78:79], v[94:95]
    v_cvt_pk_bf16_f32 v120, v64, v65
    v_cvt_pk_bf16_f32 v121, v66, v67
    v_cvt_pk_bf16_f32 v122, v68, v69
    v_cvt_pk_bf16_f32 v123, v70, v71
    buffer_store_dwordx4 v[120:123], v1, s[20:23], s66 offen offset:2048 sc1
    v_cvt_pk_bf16_f32 v124, v72, v73
    v_cvt_pk_bf16_f32 v125, v74, v75
    v_cvt_pk_bf16_f32 v126, v76, v77
    v_cvt_pk_bf16_f32 v127, v78, v79
    buffer_store_dwordx4 v[124:127], v1, s[20:23], s67 offen offset:2048 sc1
    buffer_load_dwordx4 a[140:143], v1, s[16:19], s44 offen offset:3072
    buffer_load_dwordx4 a[144:147], v1, s[16:19], s45 offen offset:3072
    buffer_load_dwordx4 a[148:151], v1, s[16:19], s46 offen offset:3072
    buffer_load_dwordx4 a[152:155], v1, s[16:19], s47 offen offset:3072
    buffer_load_dwordx4 a[156:159], v1, s[16:19], s48 offen offset:3072
    s_add_u32 s44, s44, 4096
    s_add_u32 s45, s45, 4096
    s_add_u32 s46, s46, 4096
    s_add_u32 s47, s47, 4096
    s_add_u32 s48, s48, 4096
    buffer_load_dwordx4 a[160:163], v1, s[16:19], s44 offen offset:0
    buffer_load_dwordx4 a[164:167], v1, s[16:19], s45 offen offset:0
    buffer_load_dwordx4 a[168:171], v1, s[16:19], s46 offen offset:0
    buffer_load_dwordx4 a[172:175], v1, s[16:19], s47 offen offset:0
    buffer_load_dwordx4 a[176:179], v1, s[16:19], s48 offen offset:0
    buffer_load_dwordx4 a[180:183], v1, s[16:19], s44 offen offset:1024
    buffer_load_dwordx4 a[184:187], v1, s[16:19], s45 offen offset:1024
    buffer_load_dwordx4 a[188:191], v1, s[16:19], s46 offen offset:1024
    buffer_load_dwordx4 a[192:195], v1, s[16:19], s47 offen offset:1024
    buffer_load_dwordx4 a[196:199], v1, s[16:19], s48 offen offset:1024
    s_waitcnt vmcnt(15)
    v_mov_b32 v254, 1
    v_mov_b32 v255, s70
    s_mov_b64 exec, 1
    buffer_atomic_add v254, v255, s[60:63], 0 offen
    s_mov_b64 exec, -1
    s_barrier
    buffer_load_dwordx4 a[200:203], v1, s[16:19], s44 offen offset:2048
    buffer_load_dwordx4 a[204:207], v1, s[16:19], s45 offen offset:2048
    buffer_load_dwordx4 a[208:211], v1, s[16:19], s46 offen offset:2048
    buffer_load_dwordx4 a[212:215], v1, s[16:19], s47 offen offset:2048
    buffer_load_dwordx4 a[216:219], v1, s[16:19], s48 offen offset:2048
    buffer_load_dwordx4 a[220:223], v1, s[16:19], s44 offen offset:3072
    buffer_load_dwordx4 a[224:227], v1, s[16:19], s45 offen offset:3072
    buffer_load_dwordx4 a[228:231], v1, s[16:19], s46 offen offset:3072
    buffer_load_dwordx4 a[232:235], v1, s[16:19], s47 offen offset:3072
    buffer_load_dwordx4 a[236:239], v1, s[16:19], s48 offen offset:3072
    s_mul_i32 s67, s36, 12
    s_add_u32 s66, s36, 0
    s_and_b32 s66, s66, 3
    s_lshl_b32 s39, s34, 2
    s_add_u32 s66, s66, s39
    s_mul_i32 s66, s66, 48
    s_add_u32 s66, s66, s67
    s_lshl_b32 s40, s66, 10
    s_add_u32 s66, s36, 1
    s_and_b32 s66, s66, 3
    s_lshl_b32 s39, s34, 2
    s_add_u32 s66, s66, s39
    s_mul_i32 s66, s66, 48
    s_add_u32 s66, s66, s67
    s_lshl_b32 s41, s66, 10
    s_add_u32 s66, s36, 2
    s_and_b32 s66, s66, 3
    s_lshl_b32 s39, s34, 2
    s_add_u32 s66, s66, s39
    s_mul_i32 s66, s66, 48
    s_add_u32 s66, s66, s67
    s_lshl_b32 s42, s66, 10
    s_add_u32 s66, s36, 3
    s_and_b32 s66, s66, 3
    s_lshl_b32 s39, s34, 2
    s_add_u32 s66, s66, s39
    s_mul_i32 s66, s66, 48
    s_add_u32 s66, s66, s67
    s_lshl_b32 s43, s66, 10
    s_mov_b32 s28, s24
    s_mov_b32 s29, s25
    s_mov_b32 s30, 0x500
    s_mov_b32 s31, 0x20000
    s_mov_b32 s52, s4
    s_mov_b32 s53, s5
    s_mov_b32 s54, 0x280000
    s_mov_b32 s55, 0x20000
    v_lshrrev_b32 v5, 4, v3
    v_lshlrev_b32 v5, 3, v5
    s_mul_i32 s73, s35, 160
    buffer_load_dwordx2 v[230:231], v5, s[28:31], s73 offen offset:0
    buffer_load_dwordx2 v[232:233], v5, s[28:31], s73 offen offset:32
    buffer_load_dwordx2 v[234:235], v5, s[28:31], s73 offen offset:64
    buffer_load_dwordx2 v[236:237], v5, s[28:31], s73 offen offset:96
    buffer_load_dwordx2 v[238:239], v5, s[28:31], s73 offen offset:128
    s_mov_b32 s75, 0
K2_PL_S3:
    s_load_dword s74, s[26:27], s71 glc
    s_waitcnt lgkmcnt(0)
    s_add_u32 s75, s75, 1
    s_cmp_ge_u32 s74, 8
    s_cbranch_scc1 K2_PD_S3
    s_cmp_lt_u32 s75, 2000000
    s_cbranch_scc1 K2_PL_S3
K2_PD_S3:
    buffer_load_dwordx4 v[88:91], v1, s[20:23], s40 offen offset:0 sc1
    buffer_load_dwordx4 v[92:95], v1, s[20:23], s41 offen offset:0 sc1
    buffer_load_dwordx4 v[96:99], v1, s[20:23], s42 offen offset:0 sc1
    buffer_load_dwordx4 v[100:103], v1, s[20:23], s43 offen offset:0 sc1
    buffer_load_dwordx4 v[104:107], v1, s[20:23], s40 offen offset:1024 sc1
    buffer_load_dwordx4 v[108:111], v1, s[20:23], s41 offen offset:1024 sc1
    buffer_load_dwordx4 v[112:115], v1, s[20:23], s42 offen offset:1024 sc1
    buffer_load_dwordx4 v[116:119], v1, s[20:23], s43 offen offset:1024 sc1
    buffer_load_dwordx4 v[120:123], v1, s[20:23], s40 offen offset:2048 sc1
    buffer_load_dwordx4 v[124:127], v1, s[20:23], s41 offen offset:2048 sc1
    buffer_load_dwordx4 v[128:131], v1, s[20:23], s42 offen offset:2048 sc1
    buffer_load_dwordx4 v[132:135], v1, s[20:23], s43 offen offset:2048 sc1
    buffer_load_dwordx4 v[136:139], v1, s[20:23], s40 offen offset:3072 sc1
    buffer_load_dwordx4 v[140:143], v1, s[20:23], s41 offen offset:3072 sc1
    buffer_load_dwordx4 v[144:147], v1, s[20:23], s42 offen offset:3072 sc1
    buffer_load_dwordx4 v[148:151], v1, s[20:23], s43 offen offset:3072 sc1
    s_add_u32 s40, s40, 4096
    s_add_u32 s41, s41, 4096
    s_add_u32 s42, s42, 4096
    s_add_u32 s43, s43, 4096
    buffer_load_dwordx4 v[152:155], v1, s[20:23], s40 offen offset:0 sc1
    buffer_load_dwordx4 v[156:159], v1, s[20:23], s41 offen offset:0 sc1
    buffer_load_dwordx4 v[160:163], v1, s[20:23], s42 offen offset:0 sc1
    buffer_load_dwordx4 v[164:167], v1, s[20:23], s43 offen offset:0 sc1
    buffer_load_dwordx4 v[168:171], v1, s[20:23], s40 offen offset:1024 sc1
    buffer_load_dwordx4 v[172:175], v1, s[20:23], s41 offen offset:1024 sc1
    buffer_load_dwordx4 v[176:179], v1, s[20:23], s42 offen offset:1024 sc1
    buffer_load_dwordx4 v[180:183], v1, s[20:23], s43 offen offset:1024 sc1
    buffer_load_dwordx4 v[184:187], v1, s[20:23], s40 offen offset:2048 sc1
    buffer_load_dwordx4 v[188:191], v1, s[20:23], s41 offen offset:2048 sc1
    buffer_load_dwordx4 v[192:195], v1, s[20:23], s42 offen offset:2048 sc1
    buffer_load_dwordx4 v[196:199], v1, s[20:23], s43 offen offset:2048 sc1
    s_waitcnt vmcnt(24)
    v_mfma_f32_16x16x32_bf16 v[8:11], a[0:3], v[88:91], 0
    v_mfma_f32_16x16x32_bf16 v[28:31], a[0:3], v[92:95], 0
    v_mfma_f32_16x16x32_bf16 v[48:51], a[0:3], v[96:99], 0
    v_mfma_f32_16x16x32_bf16 v[68:71], a[0:3], v[100:103], 0
    v_mfma_f32_16x16x32_bf16 v[12:15], a[4:7], v[88:91], 0
    buffer_load_dwordx4 v[200:203], v1, s[20:23], s40 offen offset:3072 sc1
    v_mfma_f32_16x16x32_bf16 v[32:35], a[4:7], v[92:95], 0
    v_mfma_f32_16x16x32_bf16 v[52:55], a[4:7], v[96:99], 0
    v_mfma_f32_16x16x32_bf16 v[72:75], a[4:7], v[100:103], 0
    v_mfma_f32_16x16x32_bf16 v[16:19], a[8:11], v[88:91], 0
    v_mfma_f32_16x16x32_bf16 v[36:39], a[8:11], v[92:95], 0
    buffer_load_dwordx4 v[204:207], v1, s[20:23], s41 offen offset:3072 sc1
    v_mfma_f32_16x16x32_bf16 v[56:59], a[8:11], v[96:99], 0
    v_mfma_f32_16x16x32_bf16 v[76:79], a[8:11], v[100:103], 0
    v_mfma_f32_16x16x32_bf16 v[20:23], a[12:15], v[88:91], 0
    v_mfma_f32_16x16x32_bf16 v[40:43], a[12:15], v[92:95], 0
    v_mfma_f32_16x16x32_bf16 v[60:63], a[12:15], v[96:99], 0
    buffer_load_dwordx4 v[208:211], v1, s[20:23], s42 offen offset:3072 sc1
    v_mfma_f32_16x16x32_bf16 v[80:83], a[12:15], v[100:103], 0
    v_mfma_f32_16x16x32_bf16 v[24:27], a[16:19], v[88:91], 0
    v_mfma_f32_16x16x32_bf16 v[44:47], a[16:19], v[92:95], 0
    v_mfma_f32_16x16x32_bf16 v[64:67], a[16:19], v[96:99], 0
    v_mfma_f32_16x16x32_bf16 v[84:87], a[16:19], v[100:103], 0
    buffer_load_dwordx4 v[212:215], v1, s[20:23], s43 offen offset:3072 sc1
    s_waitcnt vmcnt(24)
    v_mfma_f32_16x16x32_bf16 v[8:11], a[20:23], v[104:107], v[8:11]
    v_mfma_f32_16x16x32_bf16 v[28:31], a[20:23], v[108:111], v[28:31]
    v_mfma_f32_16x16x32_bf16 v[48:51], a[20:23], v[112:115], v[48:51]
    s_add_u32 s40, s40, 4096
    v_mfma_f32_16x16x32_bf16 v[68:71], a[20:23], v[116:119], v[68:71]
    v_mfma_f32_16x16x32_bf16 v[12:15], a[24:27], v[104:107], v[12:15]
    s_add_u32 s41, s41, 4096
    v_mfma_f32_16x16x32_bf16 v[32:35], a[24:27], v[108:111], v[32:35]
    v_mfma_f32_16x16x32_bf16 v[52:55], a[24:27], v[112:115], v[52:55]
    v_mfma_f32_16x16x32_bf16 v[72:75], a[24:27], v[116:119], v[72:75]
    s_add_u32 s42, s42, 4096
    v_mfma_f32_16x16x32_bf16 v[16:19], a[28:31], v[104:107], v[16:19]
    v_mfma_f32_16x16x32_bf16 v[36:39], a[28:31], v[108:111], v[36:39]
    s_add_u32 s43, s43, 4096
    v_mfma_f32_16x16x32_bf16 v[56:59], a[28:31], v[112:115], v[56:59]
    v_mfma_f32_16x16x32_bf16 v[76:79], a[28:31], v[116:119], v[76:79]
    v_mfma_f32_16x16x32_bf16 v[20:23], a[32:35], v[104:107], v[20:23]
    buffer_load_dwordx4 v[88:91], v1, s[20:23], s40 offen offset:0 sc1
    v_mfma_f32_16x16x32_bf16 v[40:43], a[32:35], v[108:111], v[40:43]
    v_mfma_f32_16x16x32_bf16 v[60:63], a[32:35], v[112:115], v[60:63]
    buffer_load_dwordx4 v[92:95], v1, s[20:23], s41 offen offset:0 sc1
    v_mfma_f32_16x16x32_bf16 v[80:83], a[32:35], v[116:119], v[80:83]
    v_mfma_f32_16x16x32_bf16 v[24:27], a[36:39], v[104:107], v[24:27]
    v_mfma_f32_16x16x32_bf16 v[44:47], a[36:39], v[108:111], v[44:47]
    buffer_load_dwordx4 v[96:99], v1, s[20:23], s42 offen offset:0 sc1
    v_mfma_f32_16x16x32_bf16 v[64:67], a[36:39], v[112:115], v[64:67]
    v_mfma_f32_16x16x32_bf16 v[84:87], a[36:39], v[116:119], v[84:87]
    buffer_load_dwordx4 v[100:103], v1, s[20:23], s43 offen offset:0 sc1
    s_waitcnt vmcnt(24)
    v_mfma_f32_16x16x32_bf16 v[8:11], a[40:43], v[120:123], v[8:11]
    v_mfma_f32_16x16x32_bf16 v[28:31], a[40:43], v[124:127], v[28:31]
    v_mfma_f32_16x16x32_bf16 v[48:51], a[40:43], v[128:131], v[48:51]
    v_mfma_f32_16x16x32_bf16 v[68:71], a[40:43], v[132:135], v[68:71]
    v_mfma_f32_16x16x32_bf16 v[12:15], a[44:47], v[120:123], v[12:15]
    buffer_load_dwordx4 v[104:107], v1, s[20:23], s40 offen offset:1024 sc1
    v_mfma_f32_16x16x32_bf16 v[32:35], a[44:47], v[124:127], v[32:35]
    v_mfma_f32_16x16x32_bf16 v[52:55], a[44:47], v[128:131], v[52:55]
    v_mfma_f32_16x16x32_bf16 v[72:75], a[44:47], v[132:135], v[72:75]
    v_mfma_f32_16x16x32_bf16 v[16:19], a[48:51], v[120:123], v[16:19]
    v_mfma_f32_16x16x32_bf16 v[36:39], a[48:51], v[124:127], v[36:39]
    buffer_load_dwordx4 v[108:111], v1, s[20:23], s41 offen offset:1024 sc1
    v_mfma_f32_16x16x32_bf16 v[56:59], a[48:51], v[128:131], v[56:59]
    v_mfma_f32_16x16x32_bf16 v[76:79], a[48:51], v[132:135], v[76:79]
    v_mfma_f32_16x16x32_bf16 v[20:23], a[52:55], v[120:123], v[20:23]
    v_mfma_f32_16x16x32_bf16 v[40:43], a[52:55], v[124:127], v[40:43]
    v_mfma_f32_16x16x32_bf16 v[60:63], a[52:55], v[128:131], v[60:63]
    buffer_load_dwordx4 v[112:115], v1, s[20:23], s42 offen offset:1024 sc1
    v_mfma_f32_16x16x32_bf16 v[80:83], a[52:55], v[132:135], v[80:83]
    v_mfma_f32_16x16x32_bf16 v[24:27], a[56:59], v[120:123], v[24:27]
    v_mfma_f32_16x16x32_bf16 v[44:47], a[56:59], v[124:127], v[44:47]
    v_mfma_f32_16x16x32_bf16 v[64:67], a[56:59], v[128:131], v[64:67]
    v_mfma_f32_16x16x32_bf16 v[84:87], a[56:59], v[132:135], v[84:87]
    buffer_load_dwordx4 v[116:119], v1, s[20:23], s43 offen offset:1024 sc1
    s_waitcnt vmcnt(24)
    v_mfma_f32_16x16x32_bf16 v[8:11], a[60:63], v[136:139], v[8:11]
    v_mfma_f32_16x16x32_bf16 v[28:31], a[60:63], v[140:143], v[28:31]
    v_mfma_f32_16x16x32_bf16 v[48:51], a[60:63], v[144:147], v[48:51]
    v_mfma_f32_16x16x32_bf16 v[68:71], a[60:63], v[148:151], v[68:71]
    v_mfma_f32_16x16x32_bf16 v[12:15], a[64:67], v[136:139], v[12:15]
    buffer_load_dwordx4 v[120:123], v1, s[20:23], s40 offen offset:2048 sc1
    v_mfma_f32_16x16x32_bf16 v[32:35], a[64:67], v[140:143], v[32:35]
    v_mfma_f32_16x16x32_bf16 v[52:55], a[64:67], v[144:147], v[52:55]
    v_mfma_f32_16x16x32_bf16 v[72:75], a[64:67], v[148:151], v[72:75]
    v_mfma_f32_16x16x32_bf16 v[16:19], a[68:71], v[136:139], v[16:19]
    v_mfma_f32_16x16x32_bf16 v[36:39], a[68:71], v[140:143], v[36:39]
    buffer_load_dwordx4 v[124:127], v1, s[20:23], s41 offen offset:2048 sc1
    v_mfma_f32_16x16x32_bf16 v[56:59], a[68:71], v[144:147], v[56:59]
    v_mfma_f32_16x16x32_bf16 v[76:79], a[68:71], v[148:151], v[76:79]
    v_mfma_f32_16x16x32_bf16 v[20:23], a[72:75], v[136:139], v[20:23]
    v_mfma_f32_16x16x32_bf16 v[40:43], a[72:75], v[140:143], v[40:43]
    v_mfma_f32_16x16x32_bf16 v[60:63], a[72:75], v[144:147], v[60:63]
    buffer_load_dwordx4 v[128:131], v1, s[20:23], s42 offen offset:2048 sc1
    v_mfma_f32_16x16x32_bf16 v[80:83], a[72:75], v[148:151], v[80:83]
    v_mfma_f32_16x16x32_bf16 v[24:27], a[76:79], v[136:139], v[24:27]
    v_mfma_f32_16x16x32_bf16 v[44:47], a[76:79], v[140:143], v[44:47]
    v_mfma_f32_16x16x32_bf16 v[64:67], a[76:79], v[144:147], v[64:67]
    v_mfma_f32_16x16x32_bf16 v[84:87], a[76:79], v[148:151], v[84:87]
    buffer_load_dwordx4 v[132:135], v1, s[20:23], s43 offen offset:2048 sc1
    s_waitcnt vmcnt(24)
    v_mfma_f32_16x16x32_bf16 v[8:11], a[80:83], v[152:155], v[8:11]
    v_mfma_f32_16x16x32_bf16 v[28:31], a[80:83], v[156:159], v[28:31]
    v_mfma_f32_16x16x32_bf16 v[48:51], a[80:83], v[160:163], v[48:51]
    v_mfma_f32_16x16x32_bf16 v[68:71], a[80:83], v[164:167], v[68:71]
    v_mfma_f32_16x16x32_bf16 v[12:15], a[84:87], v[152:155], v[12:15]
    buffer_load_dwordx4 v[136:139], v1, s[20:23], s40 offen offset:3072 sc1
    v_mfma_f32_16x16x32_bf16 v[32:35], a[84:87], v[156:159], v[32:35]
    v_mfma_f32_16x16x32_bf16 v[52:55], a[84:87], v[160:163], v[52:55]
    v_mfma_f32_16x16x32_bf16 v[72:75], a[84:87], v[164:167], v[72:75]
    v_mfma_f32_16x16x32_bf16 v[16:19], a[88:91], v[152:155], v[16:19]
    v_mfma_f32_16x16x32_bf16 v[36:39], a[88:91], v[156:159], v[36:39]
    buffer_load_dwordx4 v[140:143], v1, s[20:23], s41 offen offset:3072 sc1
    v_mfma_f32_16x16x32_bf16 v[56:59], a[88:91], v[160:163], v[56:59]
    v_mfma_f32_16x16x32_bf16 v[76:79], a[88:91], v[164:167], v[76:79]
    v_mfma_f32_16x16x32_bf16 v[20:23], a[92:95], v[152:155], v[20:23]
    v_mfma_f32_16x16x32_bf16 v[40:43], a[92:95], v[156:159], v[40:43]
    v_mfma_f32_16x16x32_bf16 v[60:63], a[92:95], v[160:163], v[60:63]
    buffer_load_dwordx4 v[144:147], v1, s[20:23], s42 offen offset:3072 sc1
    v_mfma_f32_16x16x32_bf16 v[80:83], a[92:95], v[164:167], v[80:83]
    v_mfma_f32_16x16x32_bf16 v[24:27], a[96:99], v[152:155], v[24:27]
    v_mfma_f32_16x16x32_bf16 v[44:47], a[96:99], v[156:159], v[44:47]
    v_mfma_f32_16x16x32_bf16 v[64:67], a[96:99], v[160:163], v[64:67]
    v_mfma_f32_16x16x32_bf16 v[84:87], a[96:99], v[164:167], v[84:87]
    buffer_load_dwordx4 v[148:151], v1, s[20:23], s43 offen offset:3072 sc1
    s_waitcnt vmcnt(24)
    v_mfma_f32_16x16x32_bf16 v[8:11], a[100:103], v[168:171], v[8:11]
    v_mfma_f32_16x16x32_bf16 v[28:31], a[100:103], v[172:175], v[28:31]
    v_mfma_f32_16x16x32_bf16 v[48:51], a[100:103], v[176:179], v[48:51]
    v_mfma_f32_16x16x32_bf16 v[68:71], a[100:103], v[180:183], v[68:71]
    v_mfma_f32_16x16x32_bf16 v[12:15], a[104:107], v[168:171], v[12:15]
    v_mfma_f32_16x16x32_bf16 v[32:35], a[104:107], v[172:175], v[32:35]
    v_mfma_f32_16x16x32_bf16 v[52:55], a[104:107], v[176:179], v[52:55]
    v_mfma_f32_16x16x32_bf16 v[72:75], a[104:107], v[180:183], v[72:75]
    v_mfma_f32_16x16x32_bf16 v[16:19], a[108:111], v[168:171], v[16:19]
    v_mfma_f32_16x16x32_bf16 v[36:39], a[108:111], v[172:175], v[36:39]
    v_mfma_f32_16x16x32_bf16 v[56:59], a[108:111], v[176:179], v[56:59]
    v_mfma_f32_16x16x32_bf16 v[76:79], a[108:111], v[180:183], v[76:79]
    v_mfma_f32_16x16x32_bf16 v[20:23], a[112:115], v[168:171], v[20:23]
    v_mfma_f32_16x16x32_bf16 v[40:43], a[112:115], v[172:175], v[40:43]
    v_mfma_f32_16x16x32_bf16 v[60:63], a[112:115], v[176:179], v[60:63]
    v_mfma_f32_16x16x32_bf16 v[80:83], a[112:115], v[180:183], v[80:83]
    v_mfma_f32_16x16x32_bf16 v[24:27], a[116:119], v[168:171], v[24:27]
    v_mfma_f32_16x16x32_bf16 v[44:47], a[116:119], v[172:175], v[44:47]
    v_mfma_f32_16x16x32_bf16 v[64:67], a[116:119], v[176:179], v[64:67]
    v_mfma_f32_16x16x32_bf16 v[84:87], a[116:119], v[180:183], v[84:87]
    s_waitcnt vmcnt(20)
    v_mfma_f32_16x16x32_bf16 v[8:11], a[120:123], v[184:187], v[8:11]
    v_mfma_f32_16x16x32_bf16 v[28:31], a[120:123], v[188:191], v[28:31]
    v_mfma_f32_16x16x32_bf16 v[48:51], a[120:123], v[192:195], v[48:51]
    v_mfma_f32_16x16x32_bf16 v[68:71], a[120:123], v[196:199], v[68:71]
    v_mfma_f32_16x16x32_bf16 v[12:15], a[124:127], v[184:187], v[12:15]
    v_mfma_f32_16x16x32_bf16 v[32:35], a[124:127], v[188:191], v[32:35]
    v_mfma_f32_16x16x32_bf16 v[52:55], a[124:127], v[192:195], v[52:55]
    v_mfma_f32_16x16x32_bf16 v[72:75], a[124:127], v[196:199], v[72:75]
    v_mfma_f32_16x16x32_bf16 v[16:19], a[128:131], v[184:187], v[16:19]
    v_mfma_f32_16x16x32_bf16 v[36:39], a[128:131], v[188:191], v[36:39]
    v_mfma_f32_16x16x32_bf16 v[56:59], a[128:131], v[192:195], v[56:59]
    v_mfma_f32_16x16x32_bf16 v[76:79], a[128:131], v[196:199], v[76:79]
    v_mfma_f32_16x16x32_bf16 v[20:23], a[132:135], v[184:187], v[20:23]
    v_mfma_f32_16x16x32_bf16 v[40:43], a[132:135], v[188:191], v[40:43]
    v_mfma_f32_16x16x32_bf16 v[60:63], a[132:135], v[192:195], v[60:63]
    v_mfma_f32_16x16x32_bf16 v[80:83], a[132:135], v[196:199], v[80:83]
    v_mfma_f32_16x16x32_bf16 v[24:27], a[136:139], v[184:187], v[24:27]
    v_mfma_f32_16x16x32_bf16 v[44:47], a[136:139], v[188:191], v[44:47]
    v_mfma_f32_16x16x32_bf16 v[64:67], a[136:139], v[192:195], v[64:67]
    v_mfma_f32_16x16x32_bf16 v[84:87], a[136:139], v[196:199], v[84:87]
    s_waitcnt vmcnt(16)
    v_mfma_f32_16x16x32_bf16 v[8:11], a[140:143], v[200:203], v[8:11]
    v_mfma_f32_16x16x32_bf16 v[28:31], a[140:143], v[204:207], v[28:31]
    v_mfma_f32_16x16x32_bf16 v[48:51], a[140:143], v[208:211], v[48:51]
    v_mfma_f32_16x16x32_bf16 v[68:71], a[140:143], v[212:215], v[68:71]
    v_mfma_f32_16x16x32_bf16 v[12:15], a[144:147], v[200:203], v[12:15]
    v_mfma_f32_16x16x32_bf16 v[32:35], a[144:147], v[204:207], v[32:35]
    v_mfma_f32_16x16x32_bf16 v[52:55], a[144:147], v[208:211], v[52:55]
    v_mfma_f32_16x16x32_bf16 v[72:75], a[144:147], v[212:215], v[72:75]
    v_mfma_f32_16x16x32_bf16 v[16:19], a[148:151], v[200:203], v[16:19]
    v_mfma_f32_16x16x32_bf16 v[36:39], a[148:151], v[204:207], v[36:39]
    v_mfma_f32_16x16x32_bf16 v[56:59], a[148:151], v[208:211], v[56:59]
    v_mfma_f32_16x16x32_bf16 v[76:79], a[148:151], v[212:215], v[76:79]
    v_mfma_f32_16x16x32_bf16 v[20:23], a[152:155], v[200:203], v[20:23]
    v_mfma_f32_16x16x32_bf16 v[40:43], a[152:155], v[204:207], v[40:43]
    v_mfma_f32_16x16x32_bf16 v[60:63], a[152:155], v[208:211], v[60:63]
    v_mfma_f32_16x16x32_bf16 v[80:83], a[152:155], v[212:215], v[80:83]
    v_mfma_f32_16x16x32_bf16 v[24:27], a[156:159], v[200:203], v[24:27]
    v_mfma_f32_16x16x32_bf16 v[44:47], a[156:159], v[204:207], v[44:47]
    v_mfma_f32_16x16x32_bf16 v[64:67], a[156:159], v[208:211], v[64:67]
    v_mfma_f32_16x16x32_bf16 v[84:87], a[156:159], v[212:215], v[84:87]
    s_waitcnt vmcnt(12)
    v_mfma_f32_16x16x32_bf16 v[8:11], a[160:163], v[88:91], v[8:11]
    v_mfma_f32_16x16x32_bf16 v[28:31], a[160:163], v[92:95], v[28:31]
    v_mfma_f32_16x16x32_bf16 v[48:51], a[160:163], v[96:99], v[48:51]
    v_mfma_f32_16x16x32_bf16 v[68:71], a[160:163], v[100:103], v[68:71]
    v_mfma_f32_16x16x32_bf16 v[12:15], a[164:167], v[88:91], v[12:15]
    v_mfma_f32_16x16x32_bf16 v[32:35], a[164:167], v[92:95], v[32:35]
    v_mfma_f32_16x16x32_bf16 v[52:55], a[164:167], v[96:99], v[52:55]
    v_mfma_f32_16x16x32_bf16 v[72:75], a[164:167], v[100:103], v[72:75]
    v_mfma_f32_16x16x32_bf16 v[16:19], a[168:171], v[88:91], v[16:19]
    v_mfma_f32_16x16x32_bf16 v[36:39], a[168:171], v[92:95], v[36:39]
    v_mfma_f32_16x16x32_bf16 v[56:59], a[168:171], v[96:99], v[56:59]
    v_mfma_f32_16x16x32_bf16 v[76:79], a[168:171], v[100:103], v[76:79]
    v_mfma_f32_16x16x32_bf16 v[20:23], a[172:175], v[88:91], v[20:23]
    v_mfma_f32_16x16x32_bf16 v[40:43], a[172:175], v[92:95], v[40:43]
    v_mfma_f32_16x16x32_bf16 v[60:63], a[172:175], v[96:99], v[60:63]
    v_mfma_f32_16x16x32_bf16 v[80:83], a[172:175], v[100:103], v[80:83]
    v_mfma_f32_16x16x32_bf16 v[24:27], a[176:179], v[88:91], v[24:27]
    v_mfma_f32_16x16x32_bf16 v[44:47], a[176:179], v[92:95], v[44:47]
    v_mfma_f32_16x16x32_bf16 v[64:67], a[176:179], v[96:99], v[64:67]
    v_mfma_f32_16x16x32_bf16 v[84:87], a[176:179], v[100:103], v[84:87]
    s_waitcnt vmcnt(8)
    v_mfma_f32_16x16x32_bf16 v[8:11], a[180:183], v[104:107], v[8:11]
    v_mfma_f32_16x16x32_bf16 v[28:31], a[180:183], v[108:111], v[28:31]
    v_mfma_f32_16x16x32_bf16 v[48:51], a[180:183], v[112:115], v[48:51]
    v_mfma_f32_16x16x32_bf16 v[68:71], a[180:183], v[116:119], v[68:71]
    v_mfma_f32_16x16x32_bf16 v[12:15], a[184:187], v[104:107], v[12:15]
    v_mfma_f32_16x16x32_bf16 v[32:35], a[184:187], v[108:111], v[32:35]
    v_mfma_f32_16x16x32_bf16 v[52:55], a[184:187], v[112:115], v[52:55]
    v_mfma_f32_16x16x32_bf16 v[72:75], a[184:187], v[116:119], v[72:75]
    v_mfma_f32_16x16x32_bf16 v[16:19], a[188:191], v[104:107], v[16:19]
    v_mfma_f32_16x16x32_bf16 v[36:39], a[188:191], v[108:111], v[36:39]
    v_mfma_f32_16x16x32_bf16 v[56:59], a[188:191], v[112:115], v[56:59]
    v_mfma_f32_16x16x32_bf16 v[76:79], a[188:191], v[116:119], v[76:79]
    v_mfma_f32_16x16x32_bf16 v[20:23], a[192:195], v[104:107], v[20:23]
    v_mfma_f32_16x16x32_bf16 v[40:43], a[192:195], v[108:111], v[40:43]
    v_mfma_f32_16x16x32_bf16 v[60:63], a[192:195], v[112:115], v[60:63]
    v_mfma_f32_16x16x32_bf16 v[80:83], a[192:195], v[116:119], v[80:83]
    v_mfma_f32_16x16x32_bf16 v[24:27], a[196:199], v[104:107], v[24:27]
    v_mfma_f32_16x16x32_bf16 v[44:47], a[196:199], v[108:111], v[44:47]
    v_mfma_f32_16x16x32_bf16 v[64:67], a[196:199], v[112:115], v[64:67]
    v_mfma_f32_16x16x32_bf16 v[84:87], a[196:199], v[116:119], v[84:87]
    s_waitcnt vmcnt(4)
    v_mfma_f32_16x16x32_bf16 v[8:11], a[200:203], v[120:123], v[8:11]
    v_mfma_f32_16x16x32_bf16 v[28:31], a[200:203], v[124:127], v[28:31]
    v_mfma_f32_16x16x32_bf16 v[48:51], a[200:203], v[128:131], v[48:51]
    v_mfma_f32_16x16x32_bf16 v[68:71], a[200:203], v[132:135], v[68:71]
    v_mfma_f32_16x16x32_bf16 v[12:15], a[204:207], v[120:123], v[12:15]
    v_mfma_f32_16x16x32_bf16 v[32:35], a[204:207], v[124:127], v[32:35]
    v_mfma_f32_16x16x32_bf16 v[52:55], a[204:207], v[128:131], v[52:55]
    v_mfma_f32_16x16x32_bf16 v[72:75], a[204:207], v[132:135], v[72:75]
    v_mfma_f32_16x16x32_bf16 v[16:19], a[208:211], v[120:123], v[16:19]
    v_mfma_f32_16x16x32_bf16 v[36:39], a[208:211], v[124:127], v[36:39]
    v_mfma_f32_16x16x32_bf16 v[56:59], a[208:211], v[128:131], v[56:59]
    v_mfma_f32_16x16x32_bf16 v[76:79], a[208:211], v[132:135], v[76:79]
    v_mfma_f32_16x16x32_bf16 v[20:23], a[212:215], v[120:123], v[20:23]
    v_mfma_f32_16x16x32_bf16 v[40:43], a[212:215], v[124:127], v[40:43]
    v_mfma_f32_16x16x32_bf16 v[60:63], a[212:215], v[128:131], v[60:63]
    v_mfma_f32_16x16x32_bf16 v[80:83], a[212:215], v[132:135], v[80:83]
    v_mfma_f32_16x16x32_bf16 v[24:27], a[216:219], v[120:123], v[24:27]
    v_mfma_f32_16x16x32_bf16 v[44:47], a[216:219], v[124:127], v[44:47]
    v_mfma_f32_16x16x32_bf16 v[64:67], a[216:219], v[128:131], v[64:67]
    v_mfma_f32_16x16x32_bf16 v[84:87], a[216:219], v[132:135], v[84:87]
    s_waitcnt vmcnt(0)
    v_mfma_f32_16x16x32_bf16 v[8:11], a[220:223], v[136:139], v[8:11]
    v_mfma_f32_16x16x32_bf16 v[28:31], a[220:223], v[140:143], v[28:31]
    v_mfma_f32_16x16x32_bf16 v[48:51], a[220:223], v[144:147], v[48:51]
    v_mfma_f32_16x16x32_bf16 v[68:71], a[220:223], v[148:151], v[68:71]
    v_mfma_f32_16x16x32_bf16 v[12:15], a[224:227], v[136:139], v[12:15]
    v_mfma_f32_16x16x32_bf16 v[32:35], a[224:227], v[140:143], v[32:35]
    v_mfma_f32_16x16x32_bf16 v[52:55], a[224:227], v[144:147], v[52:55]
    v_mfma_f32_16x16x32_bf16 v[72:75], a[224:227], v[148:151], v[72:75]
    v_mfma_f32_16x16x32_bf16 v[16:19], a[228:231], v[136:139], v[16:19]
    v_mfma_f32_16x16x32_bf16 v[36:39], a[228:231], v[140:143], v[36:39]
    v_mfma_f32_16x16x32_bf16 v[56:59], a[228:231], v[144:147], v[56:59]
    v_mfma_f32_16x16x32_bf16 v[76:79], a[228:231], v[148:151], v[76:79]
    v_mfma_f32_16x16x32_bf16 v[20:23], a[232:235], v[136:139], v[20:23]
    v_mfma_f32_16x16x32_bf16 v[40:43], a[232:235], v[140:143], v[40:43]
    v_mfma_f32_16x16x32_bf16 v[60:63], a[232:235], v[144:147], v[60:63]
    v_mfma_f32_16x16x32_bf16 v[80:83], a[232:235], v[148:151], v[80:83]
    v_mfma_f32_16x16x32_bf16 v[24:27], a[236:239], v[136:139], v[24:27]
    v_mfma_f32_16x16x32_bf16 v[44:47], a[236:239], v[140:143], v[44:47]
    v_mfma_f32_16x16x32_bf16 v[64:67], a[236:239], v[144:147], v[64:67]
    v_mfma_f32_16x16x32_bf16 v[84:87], a[236:239], v[148:151], v[84:87]
    s_add_u32 s66, s36, 1
    s_and_b32 s66, s66, 3
    s_mul_i32 s66, s66, 15360
    s_add_u32 s66, s66, 98304
    v_add_u32 v89, s66, v1
    s_add_u32 s66, s36, 2
    s_and_b32 s66, s66, 3
    s_mul_i32 s66, s66, 15360
    s_add_u32 s66, s66, 103424
    v_add_u32 v90, s66, v1
    s_add_u32 s66, s36, 3
    s_and_b32 s66, s66, 3
    s_mul_i32 s66, s66, 15360
    s_add_u32 s66, s66, 108544
    v_add_u32 v91, s66, v1
    ds_write_b128 v89, v[28:31] offset:0
    ds_write_b128 v89, v[32:35] offset:1024
    ds_write_b128 v89, v[36:39] offset:2048
    ds_write_b128 v89, v[40:43] offset:3072
    ds_write_b128 v89, v[44:47] offset:4096
    ds_write_b128 v90, v[48:51] offset:0
    ds_write_b128 v90, v[52:55] offset:1024
    ds_write_b128 v90, v[56:59] offset:2048
    ds_write_b128 v90, v[60:63] offset:3072
    ds_write_b128 v90, v[64:67] offset:4096
    ds_write_b128 v91, v[68:71] offset:0
    ds_write_b128 v91, v[72:75] offset:1024
    ds_write_b128 v91, v[76:79] offset:2048
    ds_write_b128 v91, v[80:83] offset:3072
    ds_write_b128 v91, v[84:87] offset:4096
    s_mul_i32 s66, s36, 15360
    s_add_u32 s66, s66, 98304
    v_add_u32 v88, s66, v1
    v_lshlrev_b32 v96, 16, v240
    v_lshlrev_b32 v100, 16, v230
    v_and_b32 v97, 0xffff0000, v240
    v_and_b32 v101, 0xffff0000, v230
    v_lshlrev_b32 v98, 16, v241
    v_lshlrev_b32 v102, 16, v231
    v_and_b32 v99, 0xffff0000, v241
    v_and_b32 v103, 0xffff0000, v231
    v_pk_add_f32 v[96:97], v[96:97], v[100:101]
    v_pk_add_f32 v[98:99], v[98:99], v[102:103]
    v_pk_add_f32 v[8:9], v[8:9], v[96:97]
    v_pk_add_f32 v[10:11], v[10:11], v[98:99]
    v_lshlrev_b32 v96, 16, v242
    v_lshlrev_b32 v100, 16, v232
    v_and_b32 v97, 0xffff0000, v242
    v_and_b32 v101, 0xffff0000, v232
    v_lshlrev_b32 v98, 16, v243
    v_lshlrev_b32 v102, 16, v233
    v_and_b32 v99, 0xffff0000, v243
    v_and_b32 v103, 0xffff0000, v233
    v_pk_add_f32 v[96:97], v[96:97], v[100:101]
    v_pk_add_f32 v[98:99], v[98:99], v[102:103]
    v_pk_add_f32 v[12:13], v[12:13], v[96:97]
    v_pk_add_f32 v[14:15], v[14:15], v[98:99]
    v_lshlrev_b32 v96, 16, v244
    v_lshlrev_b32 v100, 16, v234
    v_and_b32 v97, 0xffff0000, v244
    v_and_b32 v101, 0xffff0000, v234
    v_lshlrev_b32 v98, 16, v245
    v_lshlrev_b32 v102, 16, v235
    v_and_b32 v99, 0xffff0000, v245
    v_and_b32 v103, 0xffff0000, v235
    v_pk_add_f32 v[96:97], v[96:97], v[100:101]
    v_pk_add_f32 v[98:99], v[98:99], v[102:103]
    v_pk_add_f32 v[16:17], v[16:17], v[96:97]
    v_pk_add_f32 v[18:19], v[18:19], v[98:99]
    v_lshlrev_b32 v96, 16, v246
    v_lshlrev_b32 v100, 16, v236
    v_and_b32 v97, 0xffff0000, v246
    v_and_b32 v101, 0xffff0000, v236
    v_lshlrev_b32 v98, 16, v247
    v_lshlrev_b32 v102, 16, v237
    v_and_b32 v99, 0xffff0000, v247
    v_and_b32 v103, 0xffff0000, v237
    v_pk_add_f32 v[96:97], v[96:97], v[100:101]
    v_pk_add_f32 v[98:99], v[98:99], v[102:103]
    v_pk_add_f32 v[20:21], v[20:21], v[96:97]
    v_pk_add_f32 v[22:23], v[22:23], v[98:99]
    v_lshlrev_b32 v96, 16, v248
    v_lshlrev_b32 v100, 16, v238
    v_and_b32 v97, 0xffff0000, v248
    v_and_b32 v101, 0xffff0000, v238
    v_lshlrev_b32 v98, 16, v249
    v_lshlrev_b32 v102, 16, v239
    v_and_b32 v99, 0xffff0000, v249
    v_and_b32 v103, 0xffff0000, v239
    v_pk_add_f32 v[96:97], v[96:97], v[100:101]
    v_pk_add_f32 v[98:99], v[98:99], v[102:103]
    v_pk_add_f32 v[24:25], v[24:25], v[96:97]
    v_pk_add_f32 v[26:27], v[26:27], v[98:99]
    s_waitcnt lgkmcnt(0)
    s_barrier
    ds_read_b128 v[104:107], v88 offset:0
    ds_read_b128 v[108:111], v88 offset:1024
    ds_read_b128 v[112:115], v88 offset:2048
    ds_read_b128 v[116:119], v88 offset:3072
    ds_read_b128 v[120:123], v88 offset:4096
    ds_read_b128 v[124:127], v88 offset:5120
    ds_read_b128 v[128:131], v88 offset:6144
    ds_read_b128 v[132:135], v88 offset:7168
    ds_read_b128 v[136:139], v88 offset:8192
    ds_read_b128 v[140:143], v88 offset:9216
    ds_read_b128 v[144:147], v88 offset:10240
    ds_read_b128 v[148:151], v88 offset:11264
    ds_read_b128 v[152:155], v88 offset:12288
    ds_read_b128 v[156:159], v88 offset:13312
    ds_read_b128 v[160:163], v88 offset:14336
    v_and_b32 v6, 15, v3
    v_mul_u32_u24 v6, 1280, v6
    v_add_u32 v6, v6, v5
    s_mul_i32 s66, s51, 20480
    s_add_u32 s66, s66, s73
    s_waitcnt lgkmcnt(10)
    v_pk_add_f32 v[8:9], v[8:9], v[104:105]
    v_pk_add_f32 v[10:11], v[10:11], v[106:107]
    v_pk_add_f32 v[12:13], v[12:13], v[108:109]
    v_pk_add_f32 v[14:15], v[14:15], v[110:111]
    v_pk_add_f32 v[16:17], v[16:17], v[112:113]
    v_pk_add_f32 v[18:19], v[18:19], v[114:115]
    v_pk_add_f32 v[20:21], v[20:21], v[116:117]
    v_pk_add_f32 v[22:23], v[22:23], v[118:119]
    v_pk_add_f32 v[24:25], v[24:25], v[120:121]
    v_pk_add_f32 v[26:27], v[26:27], v[122:123]
    s_waitcnt lgkmcnt(5)
    v_pk_add_f32 v[8:9], v[8:9], v[124:125]
    v_pk_add_f32 v[10:11], v[10:11], v[126:127]
    v_pk_add_f32 v[12:13], v[12:13], v[128:129]
    v_pk_add_f32 v[14:15], v[14:15], v[130:131]
    v_pk_add_f32 v[16:17], v[16:17], v[132:133]
    v_pk_add_f32 v[18:19], v[18:19], v[134:135]
    v_pk_add_f32 v[20:21], v[20:21], v[136:137]
    v_pk_add_f32 v[22:23], v[22:23], v[138:139]
    v_pk_add_f32 v[24:25], v[24:25], v[140:141]
    v_pk_add_f32 v[26:27], v[26:27], v[142:143]
    s_waitcnt lgkmcnt(0)
    v_pk_add_f32 v[8:9], v[8:9], v[144:145]
    v_pk_add_f32 v[10:11], v[10:11], v[146:147]
    v_pk_add_f32 v[12:13], v[12:13], v[148:149]
    v_pk_add_f32 v[14:15], v[14:15], v[150:151]
    v_pk_add_f32 v[16:17], v[16:17], v[152:153]
    v_pk_add_f32 v[18:19], v[18:19], v[154:155]
    v_pk_add_f32 v[20:21], v[20:21], v[156:157]
    v_pk_add_f32 v[22:23], v[22:23], v[158:159]
    v_pk_add_f32 v[24:25], v[24:25], v[160:161]
    v_pk_add_f32 v[26:27], v[26:27], v[162:163]
    v_cvt_pk_bf16_f32 v96, v8, v9
    v_cvt_pk_bf16_f32 v97, v10, v11
    buffer_store_dwordx2 v[96:97], v6, s[52:55], s66 offen offset:0
    v_cvt_pk_bf16_f32 v98, v12, v13
    v_cvt_pk_bf16_f32 v99, v14, v15
    buffer_store_dwordx2 v[98:99], v6, s[52:55], s66 offen offset:32
    v_cvt_pk_bf16_f32 v100, v16, v17
    v_cvt_pk_bf16_f32 v101, v18, v19
    buffer_store_dwordx2 v[100:101], v6, s[52:55], s66 offen offset:64
    v_cvt_pk_bf16_f32 v102, v20, v21
    v_cvt_pk_bf16_f32 v103, v22, v23
    buffer_store_dwordx2 v[102:103], v6, s[52:55], s66 offen offset:96
    v_cvt_pk_bf16_f32 v104, v24, v25
    v_cvt_pk_bf16_f32 v105, v26, v27
    buffer_store_dwordx2 v[104:105], v6, s[52:55], s66 offen offset:128
K2_END:
    s_endpgm

.section .rodata,"a"
.p2align 6
.amdhsa_kernel p1_kernel
  .amdhsa_next_free_vgpr 256
  .amdhsa_next_free_sgpr 102
  .amdhsa_accum_offset 256
  .amdhsa_group_segment_fixed_size 0
  .amdhsa_kernarg_size 88
  .amdhsa_user_sgpr_count 2
  .amdhsa_user_sgpr_kernarg_segment_ptr 1
  .amdhsa_system_sgpr_workgroup_id_x 1
  .amdhsa_float_denorm_mode_32 3
.end_amdhsa_kernel

.p2align 6
.amdhsa_kernel k2_kernel
  .amdhsa_next_free_vgpr 512
  .amdhsa_next_free_sgpr 102
  .amdhsa_accum_offset 256
  .amdhsa_group_segment_fixed_size 0
  .amdhsa_kernarg_size 88
  .amdhsa_user_sgpr_count 2
  .amdhsa_user_sgpr_kernarg_segment_ptr 1
  .amdhsa_system_sgpr_workgroup_id_x 1
  .amdhsa_float_denorm_mode_32 3
.end_amdhsa_kernel
```
